```python
import torch

def _softmax(x, axis=-1):
    return torch.softmax(x, dim=axis)
def _gelu(x):
    return torch.nn.functional.gelu(x, approximate="tanh")
def _silu(x):
    return torch.nn.functional.silu(x)
def _sigmoid(x):
    return torch.sigmoid(x)
def _layernorm(x, axis=-1, eps=1e-5):
    m = x.mean(dim=axis, keepdim=True)
    v = x.var(dim=axis, keepdim=True, unbiased=False)
    return (x - m) / torch.sqrt(v + eps)
def _scatter_add(tgt, idx, src, axis=0):
    return tgt.clone().index_add_(axis, idx, src)
def _segment_sum(src, seg, n):
    out = torch.zeros((n,) + src.shape[1:], dtype=src.dtype)
    return out.index_add_(0, seg, src)
def _pad(x, pw):
    flat = tuple(v for pair in reversed(pw) for v in pair)
    return torch.nn.functional.pad(x, flat)

kernel_name = 'sequential_preLN__linear_kernel_hedgehog__dense_activation_squared_relu__prompt'

def setup_inputs():

    _w = (lambda a: (lambda t: t.to(torch.bfloat16) if t.is_floating_point() else t)(torch.as_tensor(a)))
    def _A_setup():
        B, S, D, H = 1, 2048, 448, 16
        Dh = D // H
        return {
            "x": _w((lambda *s: torch.randn(*s, dtype=torch.bfloat16) * 0.05)(B, S, D)),
            "wqkv": _w((lambda *s: torch.randn(*s, dtype=torch.bfloat16) * 0.2)(D, 3 * D)),
            "w_phi": _w((lambda *s: torch.randn(*s, dtype=torch.bfloat16) * 0.2)(H, Dh, Dh) * (Dh ** -0.5)),
            "wo": _w((lambda *s: torch.randn(*s, dtype=torch.bfloat16) * 0.05)(D, D)),
        }
    _A_in = _A_setup()

    def _B_setup():
        B, S, D, F = 1, 2048, 448, 1792
        return {
            "x": _w((lambda *s: torch.randn(*s, dtype=torch.bfloat16) * 0.05)(B, S, D)),
            "w1": _w((lambda *s: torch.randn(*s, dtype=torch.bfloat16) * 0.05)(D, F)),
            "b1": _w((lambda *s: torch.randn(*s, dtype=torch.bfloat16) * 0.2)(F)),
            "w2": _w((lambda *s: torch.randn(*s, dtype=torch.bfloat16) * 0.05)(F, D)),
            "b2": _w((lambda *s: torch.randn(*s, dtype=torch.bfloat16) * 1.6)(D)),
        }
    _B_in = _B_setup()

    return {
        "A_x": _A_in["x"],
        "A_wqkv": _A_in["wqkv"],
        "A_w_phi": _A_in["w_phi"],
        "A_wo": _A_in["wo"],
        "B_x": _B_in["x"],
        "B_w1": _B_in["w1"],
        "B_b1": _B_in["b1"],
        "B_w2": _B_in["w2"],
        "B_b2": _B_in["b2"],
    }

def reference(A_x, A_wqkv, A_w_phi, A_wo, B_x, B_w1, B_b1, B_w2, B_b2):
    def _A_ref(x, wqkv, w_phi, wo):
        B, S, D = x.shape
        H = 16; Dh = D // H
        qkv = (lambda x, *d: x.permute(*d))((x @ wqkv).reshape(B, S, 3, H, Dh), 2, 0, 3, 1, 4)
        q, k, v = qkv[0], qkv[1], qkv[2]
        pq = torch.einsum("bhsd,hdf->bhsf", q, w_phi)
        pk = torch.einsum("bhsd,hdf->bhsf", k, w_phi)
        phi_q = torch.concatenate([_softmax(pq, axis=-1), _softmax(-pq, axis=-1)], axis=-1)
        phi_k = torch.concatenate([_softmax(pk, axis=-1), _softmax(-pk, axis=-1)], axis=-1)
        kv = torch.einsum("bhsf,bhsd->bhfd", phi_k, v)
        z  = torch.einsum("bhsf->bhf", phi_k)
        num = torch.einsum("bhqf,bhfd->bhqd", phi_q, kv)
        den = torch.einsum("bhqf,bhf->bhq", phi_q, z)[..., None] + 1e-6
        o = num / den
        return (lambda x, *d: x.permute(*d))(o, 0, 2, 1, 3).reshape(B, S, D) @ wo

    def _B_ref(x, w1, b1, w2, b2):
        h = torch.einsum("bsd,df->bsf", x, w1) + b1
        zero = torch.zeros_like(h)
        r = torch.where(h > zero, h, zero)
        h = r * r
        out = torch.einsum("bsf,fd->bsd", h, w2) + b2
        return out

    x = A_x
    h = x + _A_ref(_layernorm(x, axis=-1), A_wqkv, A_w_phi, A_wo)
    h2 = h + _B_ref(_layernorm(h, axis=-1), B_w1, B_b1, B_w2, B_b2)
    return h2
```

```asm
; @launch grid=(256,1,1) block=(256,1,1) lds=163840
.amdgcn_target "amdgcn-amd-amdhsa--gfx950"
.text
.globl sequential_preLN__linear_kernel_hedgehog__dense_activation_squared_relu__prompt_kernel
.p2align 8
.type sequential_preLN__linear_kernel_hedgehog__dense_activation_squared_relu__prompt_kernel,@function
sequential_preLN__linear_kernel_hedgehog__dense_activation_squared_relu__prompt_kernel:
    s_cmp_ge_u32 s2, 256
    s_cbranch_scc1 L_end
    s_load_dwordx8 s[4:11], s[0:1], 0
    s_load_dwordx8 s[12:19], s[0:1], 40
    s_load_dwordx4 s[20:23], s[0:1], 72
    s_load_dwordx2 s[24:25], s[0:1], 88
    s_memrealtime s[26:27]
    v_lshrrev_b32 v2, 6, v0
    s_lshr_b32 s64, s2, 3
    s_lshl_b32 s64, s64, 11
    v_and_b32 v3, 3, v0
    v_lshl_add_u32 v3, v2, 2, v3
    v_lshl_add_u32 v3, v3, 7, s64
    v_min_u32 v3, L_code_end-L_pc-4, v3
    s_getpc_b64 s[66:67]
    L_pc:
    global_load_dword a223, v3, s[66:67]
    v_and_b32 v1, 63, v0
    v_readfirstlane_b32 s52, v2
    s_and_b32 s64, s2, 7
    s_lshr_b32 s65, s2, 3
    s_lshr_b32 s53, s64, 1
    s_and_b32 s66, s65, 3
    s_lshl2_add_u32 s53, s53, s66
    s_and_b32 s56, s64, 1
    s_lshr_b32 s67, s65, 2
    s_lshl3_add_u32 s54, s56, s67
    s_mov_b32 s55, s53
    s_add_u32 s64, s56, 14
    s_sub_u32 s56, s54, s56
    s_cmp_eq_u32 s67, 7
    s_cselect_b32 s56, s64, s56
    s_mul_i32 s64, s66, 2
    s_add_u32 s64, s64, s67
    s_sub_u32 s65, s64, 7
    s_cselect_b32 s64, s64, s65
    s_lshl2_add_u32 s68, s53, s52
    s_mul_i32 s68, s68, 28672
    s_mul_i32 s69, s54, 56
    s_mul_i32 s65, s52, 43008
    s_add_u32 s69, s69, s65
    s_lshl_b32 s65, s64, 7
    s_add_u32 s57, s65, s68
    s_lshl_b32 s72, s64, 11
    s_mul_i32 s65, s64, 172032
    s_add_u32 s79, s65, s69
    s_add_u32 s64, s64, 1
    s_cmp_eq_u32 s64, 7
    s_cselect_b32 s64, 0, s64
    s_lshl_b32 s65, s64, 7
    s_add_u32 s58, s65, s68
    s_lshl_b32 s73, s64, 11
    s_mul_i32 s65, s64, 172032
    s_add_u32 s80, s65, s69
    s_add_u32 s64, s64, 1
    s_cmp_eq_u32 s64, 7
    s_cselect_b32 s64, 0, s64
    s_lshl_b32 s65, s64, 7
    s_add_u32 s59, s65, s68
    s_lshl_b32 s74, s64, 11
    s_mul_i32 s65, s64, 172032
    s_add_u32 s81, s65, s69
    s_add_u32 s64, s64, 1
    s_cmp_eq_u32 s64, 7
    s_cselect_b32 s64, 0, s64
    s_lshl_b32 s65, s64, 7
    s_add_u32 s60, s65, s68
    s_lshl_b32 s75, s64, 11
    s_mul_i32 s65, s64, 172032
    s_add_u32 s82, s65, s69
    s_add_u32 s64, s64, 1
    s_cmp_eq_u32 s64, 7
    s_cselect_b32 s64, 0, s64
    s_lshl_b32 s65, s64, 7
    s_add_u32 s61, s65, s68
    s_lshl_b32 s76, s64, 11
    s_mul_i32 s65, s64, 172032
    s_add_u32 s83, s65, s69
    s_add_u32 s64, s64, 1
    s_cmp_eq_u32 s64, 7
    s_cselect_b32 s64, 0, s64
    s_lshl_b32 s65, s64, 7
    s_add_u32 s62, s65, s68
    s_lshl_b32 s77, s64, 11
    s_mul_i32 s65, s64, 172032
    s_add_u32 s84, s65, s69
    s_add_u32 s64, s64, 1
    s_cmp_eq_u32 s64, 7
    s_cselect_b32 s64, 0, s64
    s_lshl_b32 s65, s64, 7
    s_add_u32 s63, s65, s68
    s_lshl_b32 s78, s64, 11
    s_mul_i32 s65, s64, 172032
    s_add_u32 s85, s65, s69
    v_lshrrev_b32 v2, 3, v1
    v_mul_u32_u24 v240, 896, v2
    v_lshrrev_b32 v2, 4, v1
    v_and_b32 v3, 7, v1
    v_xor_b32 v2, v2, v3
    v_lshl_add_u32 v240, v2, 4, v240
    v_xor_b32 v2, 64, v240
    v_add_u32 v241, 6144, v2
    v_add_u32 v242, 12288, v240
    v_add_u32 v243, 18432, v2
    v_lshrrev_b32 v2, 2, v1
    v_mul_u32_u24 v244, 2688, v2
    v_and_b32 v255, 3, v1
    v_lshlrev_b32 v2, 4, v255
    v_min_u32 v2, 40, v2
    v_add_u32 v244, v244, v2
    v_add_u32 v245, 896, v244
    v_add_u32 v246, 768, v244
    s_lshl_b32 s68, s52, 12
    s_lshl_b32 s69, s52, 11
    s_waitcnt lgkmcnt(0)
    s_mov_b32 s28, s4
    s_mov_b32 s29, s5
    s_mov_b32 s30, 0x1c0000
    s_mov_b32 s31, 0x20000
    s_mov_b32 s32, s6
    s_mov_b32 s33, s7
    s_mov_b32 s34, 0x126000
    s_mov_b32 s35, 0x20000
    s_add_u32 m0, s69, 65536
    s_nop 0
    buffer_load_dwordx4 v246, s[32:35], s79 offen offset:1024 lds
    s_add_u32 m0, s69, 65536
    s_nop 0
    buffer_load_dwordx4 v245, s[32:35], s79 offen offset:0 lds
    s_add_u32 m0, s68, 0
    s_nop 0
    buffer_load_dwordx4 v240, s[28:31], s57 offen offset:0 lds
    s_add_u32 m0, s68, 0
    s_nop 0
    buffer_load_dwordx4 v241, s[28:31], s57 offen offset:1024 lds
    s_add_u32 m0, s68, 0
    s_nop 0
    buffer_load_dwordx4 v242, s[28:31], s57 offen offset:2048 lds
    s_add_u32 m0, s68, 0
    s_nop 0
    buffer_load_dwordx4 v243, s[28:31], s57 offen offset:3072 lds
    s_or_b32 s64, s2, s52
    s_cmp_lg_u32 s64, 0
    s_cbranch_scc1 L_notag_1
    s_mov_b32 s48, s22
    s_mov_b32 s49, s23
    s_mov_b32 s50, 0x100
    s_mov_b32 s51, 0x20000
    s_or_b32 s26, s26, 1
    v_mov_b32 v252, s26
    s_mov_b64 exec, 1
    buffer_store_dword v252, off, s[48:51], 0 sc1
    s_mov_b64 exec, -1
    s_waitcnt vmcnt(0)
    s_nop 0
L_notag_1:
    s_lshr_b32 s64, s2, 5
    s_mov_b32 s65, 0x4f3f2f10
    s_and_b32 s66, s2, 1
    s_cselect_b32 s65, 0x43f2f1f0, s65
    s_lshl_b32 s64, s64, 2
    s_lshr_b32 s64, s65, s64
    s_and_b32 s64, s64, 15
    s_and_b32 s65, s53, 3
    s_lshl2_add_u32 s64, s64, s65
    s_lshl2_add_u32 s64, s64, s52
    v_mov_b32 v22, 0x40000000
    s_mul_i32 s65, s64, 23
    v_add_u32 v2, s65, v1
    v_lshrrev_b32 v3, 2, v2
    v_mul_u32_u24 v3, 2688, v3
    v_and_b32 v2, 3, v2
    v_lshl_add_u32 v2, v2, 7, v3
    s_mul_i32 s65, s66, 384
    v_add_u32 v2, s65, v2
    v_cmp_gt_u32 vcc, 23, v1
    s_nop 1
    v_cndmask_b32 v2, v22, v2, vcc
    v_accvgpr_write_b32 a216, v2
    s_mul_i32 s65, s64, 40
    v_add_u32 v2, s65, v1
    v_cmp_gt_u32 vcc, 40, v1
    s_nop 1
    v_cndmask_b32 v2, v22, v2, vcc
    v_min_u32 v2, 3136, v2
    v_mul_u32_u24 v3, 9363, v2
    v_lshrrev_b32 v3, 16, v3
    v_lshlrev_b32 v2, 7, v2
    v_accvgpr_write_b32 a217, v2
    s_mul_i32 s65, s66, 1792
    v_mul_u32_u24 v22, 1792, v3
    v_lshl_add_u32 v22, v2, 1, v22
    v_add_u32 v22, s65, v22
    v_accvgpr_write_b32 a218, v22
    v_lshrrev_b32 v3, 5, v3
    v_mul_u32_u24 v3, 86016, v3
    v_add_u32 v2, v2, v3
    v_accvgpr_write_b32 a219, v2
    s_add_u32 m0, s69, 73728
    s_nop 0
    buffer_load_dwordx4 v246, s[32:35], s80 offen offset:1024 lds
    v_lshrrev_b32 v7, 5, v1
    v_and_b32 v8, 31, v1
    v_lshlrev_b32 v9, 4, v1
    v_bfe_u32 v254, v1, 2, 2
    s_mul_i32 s64, s54, 1568
    s_add_u32 s36, s8, s64
    s_addc_u32 s37, s9, 0
    s_mov_b32 s38, 1568
    s_mov_b32 s39, 0x20000
    s_add_u32 m0, s69, 73728
    s_nop 0
    buffer_load_dwordx4 v245, s[32:35], s80 offen offset:0 lds
    v_bfe_u32 v2, v8, 1, 3
    v_xor_b32 v2, v2, v7
    v_lshlrev_b32 v2, 4, v2
    v_lshl_add_u32 v2, v8, 7, v2
    s_lshl_b32 s64, s52, 5
    v_xor_b32 v2, s64, v2
    v_add_u32 v10, s68, v2
    v_xor_b32 v11, 32, v10
    s_add_u32 m0, s68, 16384
    s_nop 0
    buffer_load_dwordx4 v240, s[28:31], s58 offen offset:0 lds
    v_xor_b32 v12, 64, v10
    v_xor_b32 v13, 96, v10
    v_lshl_add_u32 v2, v7, 3, v254
    v_lshlrev_b32 v2, 6, v2
    v_bfe_u32 v3, v1, 4, 1
    v_lshl_add_u32 v2, v3, 5, v2
    v_lshl_add_u32 v2, v255, 3, v2
    v_add_u32 v17, 128000, v2
    s_add_u32 m0, s68, 16384
    s_nop 0
    buffer_load_dwordx4 v241, s[28:31], s58 offen offset:1024 lds
    v_add_u32 v2, s69, v2
    v_add_u32 v14, 65536, v2
    v_xor_b32 v15, 2048, v14
    v_xor_b32 v21, 4096, v14
    v_xor_b32 v23, 6144, v14
    v_and_b32 v2, 15, v1
    v_lshlrev_b32 v2, 6, v2
    s_add_u32 s64, s69, 66608
    s_add_u32 m0, s68, 16384
    s_nop 0
    buffer_load_dwordx4 v242, s[28:31], s58 offen offset:2048 lds
    v_add_u32 v247, s64, v2
    v_mov_b32 v24, 0x3f803f80
    v_mov_b32 v25, 0x3f803f80
    v_mov_b32 v26, 0x3f803f80
    v_mov_b32 v27, 0x3f803f80
    v_mov_b32 v30, 0
    v_mov_b32 v31, 0
    s_lshl_b32 s64, s52, 2
    s_add_u32 m0, s68, 16384
    s_nop 0
    buffer_load_dwordx4 v243, s[28:31], s58 offen offset:3072 lds
    v_lshlrev_b32 v19, 4, v8
    v_add_u32 v16, s64, v19
    s_min_u32 s64, s56, 13
    s_cmp_ge_u32 s64, 7
    s_cselect_b32 s5, 1, 0
    s_mul_i32 s65, s5, 7
    s_sub_u32 s4, s64, s65
    s_lshl_b32 s4, s4, 7
    s_lshl_b32 s6, s55, 1
    s_add_u32 m0, s69, 81920
    s_nop 0
    buffer_load_dwordx4 v246, s[32:35], s81 offen offset:1024 lds
    s_add_u32 s6, s6, s5
    s_lshl_b32 s6, s6, 1
    s_mov_b32 s3, 8
    s_cmp_lt_u32 s56, 14
    s_cselect_b32 s9, -1, 0
    s_lshr_b32 s64, s52, 1
    s_mul_i32 s64, s64, 56
    s_and_b32 s65, s52, 1
    s_add_u32 s64, s64, s65
    s_add_u32 m0, s69, 81920
    s_nop 0
    buffer_load_dwordx4 v245, s[32:35], s81 offen offset:0 lds
    s_mul_i32 s64, s64, 14336
    s_add_u32 s27, s64, s4
    s_lshl_b32 s7, s52, 13
    s_add_u32 s7, s7, 131072
    v_lshrrev_b32 v2, 2, v1
    v_lshrrev_b32 v3, 4, v1
    v_xor_b32 v2, v2, v3
    v_xor_b32 v2, s52, v2
    s_add_u32 m0, s68, 32768
    s_nop 0
    buffer_load_dwordx4 v240, s[28:31], s59 offen offset:0 lds
    v_and_b32 v2, 1, v2
    v_lshlrev_b32 v2, 6, v2
    v_lshl_add_u32 v2, v255, 4, v2
    v_lshrrev_b32 v3, 3, v1
    v_mul_u32_u24 v3, 896, v3
    v_add_u32 v4, v3, v2
    v_lshl_add_u32 v2, v7, 2, v254
    v_lshlrev_b32 v2, 7, v2
    s_add_u32 m0, s68, 32768
    s_nop 0
    buffer_load_dwordx4 v241, s[28:31], s59 offen offset:1024 lds
    v_lshrrev_b32 v3, 1, v254
    v_lshl_add_u32 v2, v3, 6, v2
    v_bfe_u32 v3, v1, 4, 1
    v_lshl_add_u32 v2, v3, 5, v2
    v_lshl_add_u32 v2, v255, 3, v2
    v_add_u32 v5, s7, v2
    v_xor_b32 v6, 64, v5
    v_lshrrev_b32 v0, 4, v1
    s_add_u32 m0, s68, 32768
    s_nop 0
    buffer_load_dwordx4 v242, s[28:31], s59 offen offset:2048 lds
    v_lshlrev_b32 v0, 3, v0
    v_lshlrev_b32 v250, 3, v1
    s_mov_b32 s40, s24
    s_mov_b32 s41, s25
    s_mov_b32 s42, 0x1000000
    s_mov_b32 s43, 0x20000
    s_and_b32 s64, s9, 1605632
    s_mov_b32 s44, s16
    s_add_u32 m0, s68, 32768
    s_nop 0
    buffer_load_dwordx4 v243, s[28:31], s59 offen offset:3072 lds
    s_mov_b32 s45, s17
    s_mov_b32 s46, s64
    s_mov_b32 s47, 0x20000
    s_bfe_u32 s86, s4, 0x20007
    s_xor_b32 s86, s86, s52
    s_mul_i32 s86, s86, 100352
    s_add_u32 s86, s86, s4
    s_waitcnt vmcnt(12)
    ds_write_b32 v247, v24 offset:0
    s_waitcnt lgkmcnt(0)
    s_barrier
    ds_read_b128 v[32:35], v10 offset:0
    ds_read_b64_tr_b16 v[192:193], v14 offset:1024
    ds_read_b64_tr_b16 v[194:195], v14 offset:1280
    ds_read_b128 v[36:39], v11 offset:0
    ds_read_b64_tr_b16 v[196:197], v15 offset:1024
    ds_read_b64_tr_b16 v[198:199], v15 offset:1280
    ds_read_b128 v[40:43], v12 offset:0
    ds_read_b64_tr_b16 v[200:201], v21 offset:1024
    ds_read_b64_tr_b16 v[202:203], v21 offset:1280
    ds_read_b128 v[44:47], v13 offset:0
    ds_read_b64_tr_b16 v[204:205], v23 offset:1024
    ds_read_b64_tr_b16 v[206:207], v23 offset:1280
    s_waitcnt lgkmcnt(0)
    v_mfma_f32_32x32x16_bf16 a[240:255], v[24:27], v[192:195], 0
    ds_read_b64_tr_b16 v[176:177], v14 offset:0
    ds_read_b64_tr_b16 v[178:179], v14 offset:256
    ds_read_b64_tr_b16 v[180:181], v15 offset:0
    v_mfma_f32_32x32x16_bf16 v[160:175], v[192:195], v[32:35], 0
    ds_read_b64_tr_b16 v[182:183], v15 offset:256
    ds_read_b64_tr_b16 v[184:185], v21 offset:0
    ds_read_b64_tr_b16 v[186:187], v21 offset:256
    v_mfma_f32_32x32x16_bf16 v[216:231], v[32:35], v[32:35], 0
    ds_read_b64_tr_b16 v[188:189], v23 offset:0
    ds_read_b64_tr_b16 v[190:191], v23 offset:256
    s_add_u32 m0, s69, 90112
    s_nop 0
    buffer_load_dwordx4 v246, s[32:35], s82 offen offset:1024 lds
    v_mfma_f32_32x32x16_bf16 v[160:175], v[196:199], v[36:39], v[160:175]
    v_mfma_f32_32x32x16_bf16 v[216:231], v[36:39], v[36:39], v[216:231]
    s_add_u32 m0, s69, 90112
    s_nop 0
    buffer_load_dwordx4 v245, s[32:35], s82 offen offset:0 lds
    v_mfma_f32_32x32x16_bf16 v[160:175], v[200:203], v[40:43], v[160:175]
    s_waitcnt vmcnt(8)
    ds_write_b32 v247, v24 offset:8192
    v_mfma_f32_32x32x16_bf16 v[160:175], v[204:207], v[44:47], v[160:175]
    s_add_u32 m0, s68, 49152
    s_nop 0
    buffer_load_dwordx4 v240, s[28:31], s60 offen offset:0 lds
    s_waitcnt lgkmcnt(0)
    s_barrier
    v_mfma_f32_32x32x16_bf16 a[224:239], v[24:27], v[176:179], 0
    ds_read_b128 v[48:51], v10 offset:16384
    ds_read_b128 v[52:55], v11 offset:16384
    s_add_u32 m0, s68, 49152
    s_nop 0
    buffer_load_dwordx4 v241, s[28:31], s60 offen offset:1024 lds
    v_mfma_f32_32x32x16_bf16 v[144:159], v[176:179], v[32:35], 0
    ds_read_b128 v[56:59], v12 offset:16384
    ds_read_b128 v[60:63], v13 offset:16384
    v_mfma_f32_32x32x16_bf16 v[216:231], v[40:43], v[40:43], v[216:231]
    ds_read_b64_tr_b16 v[192:193], v14 offset:9216
    ds_read_b64_tr_b16 v[194:195], v14 offset:9472
    ds_read_b64_tr_b16 v[196:197], v15 offset:9216
    s_add_u32 m0, s68, 49152
    s_nop 0
    buffer_load_dwordx4 v242, s[28:31], s60 offen offset:2048 lds
    v_mfma_f32_32x32x16_bf16 v[144:159], v[180:183], v[36:39], v[144:159]
    ds_read_b64_tr_b16 v[198:199], v15 offset:9472
    ds_read_b64_tr_b16 v[200:201], v21 offset:9216
    ds_read_b64_tr_b16 v[202:203], v21 offset:9472
    v_mfma_f32_32x32x16_bf16 v[216:231], v[44:47], v[44:47], v[216:231]
    ds_read_b64_tr_b16 v[204:205], v23 offset:9216
    ds_read_b64_tr_b16 v[206:207], v23 offset:9472
    s_add_u32 m0, s68, 49152
    s_nop 0
    buffer_load_dwordx4 v243, s[28:31], s60 offen offset:3072 lds
    v_mfma_f32_32x32x16_bf16 v[144:159], v[184:187], v[40:43], v[144:159]
    v_mfma_f32_32x32x16_bf16 v[144:159], v[188:191], v[44:47], v[144:159]
    s_waitcnt lgkmcnt(0)
    v_mfma_f32_32x32x16_bf16 a[240:255], v[24:27], v[192:195], a[240:255]
    ds_read_b64_tr_b16 v[176:177], v14 offset:8192
    ds_read_b64_tr_b16 v[178:179], v14 offset:8448
    ds_read_b64_tr_b16 v[180:181], v15 offset:8192
    v_mfma_f32_32x32x16_bf16 v[160:175], v[192:195], v[48:51], v[160:175]
    ds_read_b64_tr_b16 v[182:183], v15 offset:8448
    ds_read_b64_tr_b16 v[184:185], v21 offset:8192
    ds_read_b64_tr_b16 v[186:187], v21 offset:8448
    v_mfma_f32_32x32x16_bf16 v[216:231], v[48:51], v[48:51], v[216:231]
    ds_read_b64_tr_b16 v[188:189], v23 offset:8192
    ds_read_b64_tr_b16 v[190:191], v23 offset:8448
    s_add_u32 m0, s69, 65536
    s_nop 0
    buffer_load_dwordx4 v246, s[32:35], s83 offen offset:1024 lds
    v_mfma_f32_32x32x16_bf16 v[160:175], v[196:199], v[52:55], v[160:175]
    s_add_u32 m0, s69, 65536
    s_nop 0
    buffer_load_dwordx4 v245, s[32:35], s83 offen offset:0 lds
    v_mfma_f32_32x32x16_bf16 v[216:231], v[52:55], v[52:55], v[216:231]
    s_add_u32 m0, s68, 0
    s_nop 0
    buffer_load_dwordx4 v240, s[28:31], s61 offen offset:0 lds
    v_mfma_f32_32x32x16_bf16 v[160:175], v[200:203], v[56:59], v[160:175]
    s_waitcnt vmcnt(9)
    ds_write_b32 v247, v24 offset:16384
    v_mfma_f32_32x32x16_bf16 v[160:175], v[204:207], v[60:63], v[160:175]
    s_add_u32 m0, s68, 0
    s_nop 0
    buffer_load_dwordx4 v241, s[28:31], s61 offen offset:1024 lds
    s_waitcnt lgkmcnt(0)
    s_barrier
    v_mfma_f32_32x32x16_bf16 a[224:239], v[24:27], v[176:179], a[224:239]
    ds_read_b128 v[64:67], v10 offset:32768
    ds_read_b128 v[68:71], v11 offset:32768
    s_add_u32 m0, s68, 0
    s_nop 0
    buffer_load_dwordx4 v242, s[28:31], s61 offen offset:2048 lds
    v_mfma_f32_32x32x16_bf16 v[144:159], v[176:179], v[48:51], v[144:159]
    ds_read_b128 v[72:75], v12 offset:32768
    ds_read_b128 v[76:79], v13 offset:32768
    v_mfma_f32_32x32x16_bf16 v[216:231], v[56:59], v[56:59], v[216:231]
    ds_read_b64_tr_b16 v[192:193], v14 offset:17408
    ds_read_b64_tr_b16 v[194:195], v14 offset:17664
    ds_read_b64_tr_b16 v[196:197], v15 offset:17408
    s_add_u32 m0, s68, 0
    s_nop 0
    buffer_load_dwordx4 v243, s[28:31], s61 offen offset:3072 lds
    v_mfma_f32_32x32x16_bf16 v[144:159], v[180:183], v[52:55], v[144:159]
    ds_read_b64_tr_b16 v[198:199], v15 offset:17664
    ds_read_b64_tr_b16 v[200:201], v21 offset:17408
    ds_read_b64_tr_b16 v[202:203], v21 offset:17664
    v_mfma_f32_32x32x16_bf16 v[216:231], v[60:63], v[60:63], v[216:231]
    ds_read_b64_tr_b16 v[204:205], v23 offset:17408
    ds_read_b64_tr_b16 v[206:207], v23 offset:17664
    s_add_u32 m0, s69, 73728
    s_nop 0
    buffer_load_dwordx4 v246, s[32:35], s84 offen offset:1024 lds
    v_mfma_f32_32x32x16_bf16 v[144:159], v[184:187], v[56:59], v[144:159]
    s_add_u32 m0, s69, 73728
    s_nop 0
    buffer_load_dwordx4 v245, s[32:35], s84 offen offset:0 lds
    v_mfma_f32_32x32x16_bf16 v[144:159], v[188:191], v[60:63], v[144:159]
    s_waitcnt lgkmcnt(0)
    v_mfma_f32_32x32x16_bf16 a[240:255], v[24:27], v[192:195], a[240:255]
    ds_read_b64_tr_b16 v[176:177], v14 offset:16384
    ds_read_b64_tr_b16 v[178:179], v14 offset:16640
    ds_read_b64_tr_b16 v[180:181], v15 offset:16384
    v_mfma_f32_32x32x16_bf16 v[160:175], v[192:195], v[64:67], v[160:175]
    ds_read_b64_tr_b16 v[182:183], v15 offset:16640
    ds_read_b64_tr_b16 v[184:185], v21 offset:16384
    ds_read_b64_tr_b16 v[186:187], v21 offset:16640
    v_mfma_f32_32x32x16_bf16 v[216:231], v[64:67], v[64:67], v[216:231]
    ds_read_b64_tr_b16 v[188:189], v23 offset:16384
    ds_read_b64_tr_b16 v[190:191], v23 offset:16640
    s_add_u32 m0, s68, 16384
    s_nop 0
    buffer_load_dwordx4 v240, s[28:31], s62 offen offset:0 lds
    v_mfma_f32_32x32x16_bf16 v[160:175], v[196:199], v[68:71], v[160:175]
    s_add_u32 m0, s68, 16384
    s_nop 0
    buffer_load_dwordx4 v241, s[28:31], s62 offen offset:1024 lds
    v_mfma_f32_32x32x16_bf16 v[216:231], v[68:71], v[68:71], v[216:231]
    s_add_u32 m0, s68, 16384
    s_nop 0
    buffer_load_dwordx4 v242, s[28:31], s62 offen offset:2048 lds
    v_mfma_f32_32x32x16_bf16 v[160:175], v[200:203], v[72:75], v[160:175]
    s_waitcnt vmcnt(11)
    ds_write_b32 v247, v24 offset:24576
    v_mfma_f32_32x32x16_bf16 v[160:175], v[204:207], v[76:79], v[160:175]
    s_add_u32 m0, s68, 16384
    s_nop 0
    buffer_load_dwordx4 v243, s[28:31], s62 offen offset:3072 lds
    s_waitcnt lgkmcnt(0)
    s_barrier
    v_mfma_f32_32x32x16_bf16 a[224:239], v[24:27], v[176:179], a[224:239]
    ds_read_b128 v[80:83], v10 offset:49152
    ds_read_b128 v[84:87], v11 offset:49152
    s_add_u32 m0, s69, 81920
    s_nop 0
    buffer_load_dwordx4 v246, s[32:35], s85 offen offset:1024 lds
    v_mfma_f32_32x32x16_bf16 v[144:159], v[176:179], v[64:67], v[144:159]
    ds_read_b128 v[88:91], v12 offset:49152
    ds_read_b128 v[92:95], v13 offset:49152
    v_mfma_f32_32x32x16_bf16 v[216:231], v[72:75], v[72:75], v[216:231]
    ds_read_b64_tr_b16 v[192:193], v14 offset:25600
    ds_read_b64_tr_b16 v[194:195], v14 offset:25856
    ds_read_b64_tr_b16 v[196:197], v15 offset:25600
    s_add_u32 m0, s69, 81920
    s_nop 0
    buffer_load_dwordx4 v245, s[32:35], s85 offen offset:0 lds
    v_mfma_f32_32x32x16_bf16 v[144:159], v[180:183], v[68:71], v[144:159]
    ds_read_b64_tr_b16 v[198:199], v15 offset:25856
    ds_read_b64_tr_b16 v[200:201], v21 offset:25600
    ds_read_b64_tr_b16 v[202:203], v21 offset:25856
    v_mfma_f32_32x32x16_bf16 v[216:231], v[76:79], v[76:79], v[216:231]
    ds_read_b64_tr_b16 v[204:205], v23 offset:25600
    ds_read_b64_tr_b16 v[206:207], v23 offset:25856
    s_add_u32 m0, s68, 32768
    s_nop 0
    buffer_load_dwordx4 v240, s[28:31], s63 offen offset:0 lds
    v_mfma_f32_32x32x16_bf16 v[144:159], v[184:187], v[72:75], v[144:159]
    s_add_u32 m0, s68, 32768
    s_nop 0
    buffer_load_dwordx4 v241, s[28:31], s63 offen offset:1024 lds
    v_mfma_f32_32x32x16_bf16 v[144:159], v[188:191], v[76:79], v[144:159]
    s_waitcnt lgkmcnt(0)
    v_mfma_f32_32x32x16_bf16 a[240:255], v[24:27], v[192:195], a[240:255]
    ds_read_b64_tr_b16 v[176:177], v14 offset:24576
    ds_read_b64_tr_b16 v[178:179], v14 offset:24832
    ds_read_b64_tr_b16 v[180:181], v15 offset:24576
    v_mfma_f32_32x32x16_bf16 v[160:175], v[192:195], v[80:83], v[160:175]
    ds_read_b64_tr_b16 v[182:183], v15 offset:24832
    ds_read_b64_tr_b16 v[184:185], v21 offset:24576
    ds_read_b64_tr_b16 v[186:187], v21 offset:24832
    v_mfma_f32_32x32x16_bf16 v[216:231], v[80:83], v[80:83], v[216:231]
    ds_read_b64_tr_b16 v[188:189], v23 offset:24576
    ds_read_b64_tr_b16 v[190:191], v23 offset:24832
    s_add_u32 m0, s68, 32768
    s_nop 0
    buffer_load_dwordx4 v242, s[28:31], s63 offen offset:2048 lds
    v_mfma_f32_32x32x16_bf16 v[160:175], v[196:199], v[84:87], v[160:175]
    s_add_u32 m0, s68, 32768
    s_nop 0
    buffer_load_dwordx4 v243, s[28:31], s63 offen offset:3072 lds
    v_mfma_f32_32x32x16_bf16 v[216:231], v[84:87], v[84:87], v[216:231]
    v_lshrrev_b32 v2, 4, v1
    s_lshr_b32 s64, s52, 1
    s_lshl_b32 s64, s64, 4
    s_and_b32 s65, s52, 1
    s_lshl_b32 s66, s65, 2
    s_add_u32 s64, s64, s66
    v_add_u32 v2, s64, v2
    v_and_b32 v3, 15, v1
    v_min_u32 v3, 13, v3
    v_lshlrev_b32 v3, 2, v3
    v_mad_u32_u24 v240, v2, 56, v3
    s_lshr_b32 s64, s52, 1
    s_lshl_b32 s64, s64, 11
    s_lshl_b32 s65, s65, 9
    s_add_u32 s64, s64, s65
    s_add_u32 m0, s64, 128000
    v_add_u32 v241, 192, v240
    s_cmp_eq_u32 s52, 2
    s_cselect_b32 s65, 0x40000000, 0
    s_cmp_eq_u32 s52, 3
    s_cselect_b32 s65, 0xffffff20, s65
    v_add_u32 v241, s65, v241
    buffer_load_dword v240, s[36:39], 0 offen lds
    buffer_load_dword v241, s[36:39], 0 offen offset:256 lds
    v_mfma_f32_32x32x16_bf16 v[160:175], v[200:203], v[88:91], v[160:175]
    s_waitcnt vmcnt(14)
    ds_write_b32 v247, v24 offset:0
    v_mfma_f32_32x32x16_bf16 v[160:175], v[204:207], v[92:95], v[160:175]
    s_mov_b32 s48, s22
    s_mov_b32 s49, s23
    s_mov_b32 s50, 0x100
    s_mov_b32 s51, 0x20000
    buffer_load_dword v252, off, s[48:51], 0 sc1
    s_waitcnt lgkmcnt(0)
    s_barrier
    v_mfma_f32_32x32x16_bf16 a[224:239], v[24:27], v[176:179], a[224:239]
    ds_read_b128 v[96:99], v10 offset:0
    ds_read_b128 v[100:103], v11 offset:0
    s_add_u32 m0, s69, 98304
    s_nop 0
    buffer_load_dwordx4 v244, s[32:35], s79 offen offset:0 lds
    v_mfma_f32_32x32x16_bf16 v[144:159], v[176:179], v[80:83], v[144:159]
    ds_read_b128 v[104:107], v12 offset:0
    ds_read_b128 v[108:111], v13 offset:0
    v_mfma_f32_32x32x16_bf16 v[216:231], v[88:91], v[88:91], v[216:231]
    ds_read_b64_tr_b16 v[192:193], v14 offset:1024
    ds_read_b64_tr_b16 v[194:195], v14 offset:1280
    ds_read_b64_tr_b16 v[196:197], v15 offset:1024
    s_add_u32 m0, s69, 99328
    s_nop 0
    buffer_load_dwordx4 v244, s[32:35], s80 offen offset:0 lds
    v_mfma_f32_32x32x16_bf16 v[144:159], v[180:183], v[84:87], v[144:159]
    ds_read_b64_tr_b16 v[198:199], v15 offset:1280
    ds_read_b64_tr_b16 v[200:201], v21 offset:1024
    ds_read_b64_tr_b16 v[202:203], v21 offset:1280
    v_mfma_f32_32x32x16_bf16 v[216:231], v[92:95], v[92:95], v[216:231]
    ds_read_b64_tr_b16 v[204:205], v23 offset:1024
    ds_read_b64_tr_b16 v[206:207], v23 offset:1280
    v_mfma_f32_32x32x16_bf16 v[144:159], v[184:187], v[88:91], v[144:159]
    v_mfma_f32_32x32x16_bf16 v[144:159], v[188:191], v[92:95], v[144:159]
    s_waitcnt lgkmcnt(0)
    v_mfma_f32_32x32x16_bf16 a[240:255], v[24:27], v[192:195], a[240:255]
    ds_read_b64_tr_b16 v[176:177], v14 offset:0
    ds_read_b64_tr_b16 v[178:179], v14 offset:256
    ds_read_b64_tr_b16 v[180:181], v15 offset:0
    v_mfma_f32_32x32x16_bf16 v[160:175], v[192:195], v[96:99], v[160:175]
    ds_read_b64_tr_b16 v[182:183], v15 offset:256
    ds_read_b64_tr_b16 v[184:185], v21 offset:0
    ds_read_b64_tr_b16 v[186:187], v21 offset:256
    v_mfma_f32_32x32x16_bf16 v[216:231], v[96:99], v[96:99], v[216:231]
    ds_read_b64_tr_b16 v[188:189], v23 offset:0
    ds_read_b64_tr_b16 v[190:191], v23 offset:256
    v_mfma_f32_32x32x16_bf16 v[160:175], v[196:199], v[100:103], v[160:175]
    v_mfma_f32_32x32x16_bf16 v[216:231], v[100:103], v[100:103], v[216:231]
    v_mfma_f32_32x32x16_bf16 v[160:175], v[200:203], v[104:107], v[160:175]
    s_waitcnt vmcnt(11)
    ds_write_b32 v247, v24 offset:8192
    v_mfma_f32_32x32x16_bf16 v[160:175], v[204:207], v[108:111], v[160:175]
    s_waitcnt lgkmcnt(0)
    s_barrier
    v_mfma_f32_32x32x16_bf16 a[224:239], v[24:27], v[176:179], a[224:239]
    ds_read_b128 v[112:115], v10 offset:16384
    ds_read_b128 v[116:119], v11 offset:16384
    s_add_u32 m0, s69, 106496
    s_nop 0
    buffer_load_dwordx4 v244, s[32:35], s81 offen offset:0 lds
    v_mfma_f32_32x32x16_bf16 v[144:159], v[176:179], v[96:99], v[144:159]
    ds_read_b128 v[120:123], v12 offset:16384
    ds_read_b128 v[124:127], v13 offset:16384
    v_mfma_f32_32x32x16_bf16 v[216:231], v[104:107], v[104:107], v[216:231]
    ds_read_b64_tr_b16 v[192:193], v14 offset:9216
    ds_read_b64_tr_b16 v[194:195], v14 offset:9472
    ds_read_b64_tr_b16 v[196:197], v15 offset:9216
    v_accvgpr_read_b32 v22, a217
    s_mov_b32 s88, s10
    s_mov_b32 s89, s11
    s_mov_b32 s90, 0x62000
    s_mov_b32 s91, 0x20000
    buffer_load_dword a223, v22, s[88:91], 0 offen
    v_mfma_f32_32x32x16_bf16 v[144:159], v[180:183], v[100:103], v[144:159]
    ds_read_b64_tr_b16 v[198:199], v15 offset:9472
    ds_read_b64_tr_b16 v[200:201], v21 offset:9216
    ds_read_b64_tr_b16 v[202:203], v21 offset:9472
    v_mfma_f32_32x32x16_bf16 v[216:231], v[108:111], v[108:111], v[216:231]
    ds_read_b64_tr_b16 v[204:205], v23 offset:9216
    ds_read_b64_tr_b16 v[206:207], v23 offset:9472
    v_accvgpr_read_b32 v22, a218
    s_mov_b32 s88, s12
    s_mov_b32 s89, s13
    s_mov_b32 s90, 0x188000
    s_mov_b32 s91, 0x20000
    buffer_load_dword a223, v22, s[88:91], 0 offen
    v_mfma_f32_32x32x16_bf16 v[144:159], v[184:187], v[104:107], v[144:159]
    v_mfma_f32_32x32x16_bf16 v[144:159], v[188:191], v[108:111], v[144:159]
    s_waitcnt lgkmcnt(0)
    v_mfma_f32_32x32x16_bf16 a[240:255], v[24:27], v[192:195], a[240:255]
    ds_read_b64_tr_b16 v[176:177], v14 offset:8192
    ds_read_b64_tr_b16 v[178:179], v14 offset:8448
    ds_read_b64_tr_b16 v[180:181], v15 offset:8192
    v_mfma_f32_32x32x16_bf16 v[160:175], v[192:195], v[112:115], v[160:175]
    ds_read_b64_tr_b16 v[182:183], v15 offset:8448
    ds_read_b64_tr_b16 v[184:185], v21 offset:8192
    ds_read_b64_tr_b16 v[186:187], v21 offset:8448
    v_mfma_f32_32x32x16_bf16 v[216:231], v[112:115], v[112:115], v[216:231]
    ds_read_b64_tr_b16 v[188:189], v23 offset:8192
    ds_read_b64_tr_b16 v[190:191], v23 offset:8448
    v_mfma_f32_32x32x16_bf16 v[160:175], v[196:199], v[116:119], v[160:175]
    v_mfma_f32_32x32x16_bf16 v[216:231], v[116:119], v[116:119], v[216:231]
    v_mfma_f32_32x32x16_bf16 v[160:175], v[200:203], v[120:123], v[160:175]
    s_waitcnt vmcnt(8)
    ds_write_b32 v247, v24 offset:16384
    v_mfma_f32_32x32x16_bf16 v[160:175], v[204:207], v[124:127], v[160:175]
    s_waitcnt lgkmcnt(0)
    s_barrier
    v_mfma_f32_32x32x16_bf16 a[224:239], v[24:27], v[176:179], a[224:239]
    ds_read_b128 v[128:131], v10 offset:32768
    ds_read_b128 v[132:135], v11 offset:32768
    v_accvgpr_read_b32 v22, a218
    s_mov_b32 s88, s12
    s_mov_b32 s89, s13
    s_mov_b32 s90, 0x188000
    s_mov_b32 s91, 0x20000
    s_mov_b32 s87, 0x80
    buffer_load_dword a223, v22, s[88:91], s87 offen
    v_mfma_f32_32x32x16_bf16 v[144:159], v[176:179], v[112:115], v[144:159]
    ds_read_b128 v[136:139], v12 offset:32768
    ds_read_b128 v[140:143], v13 offset:32768
    v_mfma_f32_32x32x16_bf16 v[216:231], v[120:123], v[120:123], v[216:231]
    ds_read_b64_tr_b16 v[192:193], v14 offset:17408
    ds_read_b64_tr_b16 v[194:195], v14 offset:17664
    ds_read_b64_tr_b16 v[196:197], v15 offset:17408
    v_mfma_f32_32x32x16_bf16 v[144:159], v[180:183], v[116:119], v[144:159]
    ds_read_b64_tr_b16 v[198:199], v15 offset:17664
    ds_read_b64_tr_b16 v[200:201], v21 offset:17408
    ds_read_b64_tr_b16 v[202:203], v21 offset:17664
    v_mfma_f32_32x32x16_bf16 v[216:231], v[124:127], v[124:127], v[216:231]
    ds_read_b64_tr_b16 v[204:205], v23 offset:17408
    ds_read_b64_tr_b16 v[206:207], v23 offset:17664
    v_mfma_f32_32x32x16_bf16 v[144:159], v[184:187], v[120:123], v[144:159]
    v_mfma_f32_32x32x16_bf16 v[144:159], v[188:191], v[124:127], v[144:159]
    v_add_u32 v16, 0x10000, v16
    v_add_u32 v19, 0x10000, v19
    s_waitcnt lgkmcnt(0)
    v_mfma_f32_32x32x16_bf16 a[240:255], v[24:27], v[192:195], a[240:255]
    ds_read_b64_tr_b16 v[176:177], v14 offset:16384
    ds_read_b64_tr_b16 v[178:179], v14 offset:16640
    ds_read_b64_tr_b16 v[180:181], v15 offset:16384
    ds_read_b64_tr_b16 v[182:183], v15 offset:16640
    v_mfma_f32_32x32x16_bf16 v[216:231], v[128:131], v[128:131], v[216:231]
    ds_read_b64_tr_b16 v[184:185], v21 offset:16384
    ds_read_b64_tr_b16 v[186:187], v21 offset:16640
    ds_read_b64_tr_b16 v[188:189], v23 offset:16384
    ds_read_b64_tr_b16 v[190:191], v23 offset:16640
    v_mfma_f32_32x32x16_bf16 v[216:231], v[132:135], v[132:135], v[216:231]
    s_waitcnt lgkmcnt(6)
    v_mfma_f32_32x32x16_bf16 a[224:239], v[24:27], v[176:179], a[224:239]
    v_mfma_f32_32x32x16_bf16 v[216:231], v[136:139], v[136:139], v[216:231]
    v_mfma_f32_32x32x16_bf16 v[216:231], v[140:143], v[140:143], v[216:231]
    v_mfma_f32_32x32x16_bf16 v[160:175], v[192:195], v[128:131], v[160:175]
    v_accvgpr_read_b32 v2, a240
    s_nop 7
    v_accvgpr_read_b32 v3, a224
    ds_write_b32 v16, v2 offset:58368
    ds_write_b32 v16, v3 offset:58880
    s_waitcnt vmcnt(7)
    s_waitcnt lgkmcnt(0)
    s_barrier
    v_mfma_f32_32x32x16_bf16 v[160:175], v[196:199], v[132:135], v[160:175]
    ds_read_b128 v[208:211], v19 offset:58368
    ds_read_b128 v[212:215], v19 offset:58880
    ds_read_b64_tr_b16 v[232:233], v17 offset:0
    ds_read_b64_tr_b16 v[234:235], v17 offset:256
    ds_read_b64_tr_b16 v[236:237], v17 offset:2048
    ds_read_b64_tr_b16 v[238:239], v17 offset:2304
    s_mov_b32 s100, 0xaaaaaaaa
    s_mov_b32 s101, 0xaaaaaaaa
    v_cndmask_b32 v216, v216, v217, s[100:101]
    v_cndmask_b32 v218, v218, v219, s[100:101]
    v_mfma_f32_32x32x16_bf16 v[160:175], v[200:203], v[136:139], v[160:175]
    v_cndmask_b32 v220, v220, v221, s[100:101]
    v_cndmask_b32 v222, v222, v223, s[100:101]
    v_cndmask_b32 v224, v224, v225, s[100:101]
    v_cndmask_b32 v226, v226, v227, s[100:101]
    v_cndmask_b32 v228, v228, v229, s[100:101]
    v_cndmask_b32 v230, v230, v231, s[100:101]
    s_mov_b32 s100, 0xcccccccc
    s_mov_b32 s101, 0xcccccccc
    v_cndmask_b32 v216, v216, v218, s[100:101]
    v_cndmask_b32 v220, v220, v222, s[100:101]
    v_cndmask_b32 v224, v224, v226, s[100:101]
    v_cndmask_b32 v228, v228, v230, s[100:101]
    v_mfma_f32_32x32x16_bf16 v[160:175], v[204:207], v[140:143], v[160:175]
    s_mov_b32 s100, 0xff00ff00
    s_mov_b32 s101, 0xff00ff00
    v_cndmask_b32 v216, v216, v220, s[100:101]
    v_cndmask_b32 v224, v224, v228, s[100:101]
    s_mov_b32 s100, 0xffff0000
    s_mov_b32 s101, 0xffff0000
    v_cndmask_b32 v216, v216, v224, s[100:101]
    v_mov_b32 v18, v216
    s_mov_b32 s100, 0xf0f0f0f0
    s_mov_b32 s101, 0xf0f0f0f0
    v_cmp_gt_u32 vcc, 32, v1
    v_permlane32_swap_b32 v18, v216
    v_cndmask_b32 v18, v18, v216, s[100:101]
    v_mul_f32 v18, 0x3b124925, v18
    s_waitcnt lgkmcnt(5)
    v_mfma_f32_32x32x16_bf16 v[144:159], v[176:179], v[128:131], v[144:159]
    v_add_f32 v208, v208, v209
    v_add_f32 v210, v210, v211
    v_mov_b32 v222, 0
    v_add_f32 v208, v208, v210
    v_mov_b32 v223, 0
    v_cndmask_b32 v208, 0, v208, vcc
    v_cvt_pk_bf16_f32 v221, v208, 0
    v_lshlrev_b32 v3, 16, v221
    v_sub_f32 v3, v208, v3
    v_cvt_pk_bf16_f32 v220, v208, v3
    v_mov_b32 v16, v172
    v_mov_b32 v17, v172
    s_nop 1
    v_permlane32_swap_b32 v16, v17
    v_mfma_f32_32x32x16_bf16 v[144:159], v[180:183], v[132:135], v[144:159]
    v_mul_f32 v16, 0xbb124925, v16
    v_cvt_pk_bf16_f32 v28, v16, v16
    v_lshlrev_b32 v2, 16, v28
    v_sub_f32 v2, v16, v2
    v_cvt_pk_bf16_f32 v29, v2, 0
    s_waitcnt lgkmcnt(4)
    s_nop 0
    v_mfma_f32_32x32x16_bf16 v[160:175], v[220:223], v[28:31], v[160:175]
    v_add_f32 v212, v212, v213
    v_add_f32 v214, v214, v215
    v_mov_b32 v226, 0
    v_add_f32 v212, v212, v214
    v_mov_b32 v227, 0
    v_cndmask_b32 v212, 0, v212, vcc
    v_fma_f32 v18, -v16, v16, v18
    v_max_f32 v18, 0, v18
    v_add_f32 v18, 0x3727c5ac, v18
    v_mfma_f32_32x32x16_bf16 v[144:159], v[184:187], v[136:139], v[144:159]
    v_cvt_pk_bf16_f32 v225, v212, 0
    v_lshlrev_b32 v3, 16, v225
    v_sub_f32 v3, v212, v3
    v_cvt_pk_bf16_f32 v224, v212, v3
    v_rsq_f32 v22, v18
    s_nop 0
    v_mfma_f32_32x32x16_bf16 v[144:159], v[224:227], v[28:31], v[144:159]
    v_mul_f32 v20, 0x3fb8aa3b, v22
    v_mul_f32 v160, v22, v160
    v_mul_f32 v161, v22, v161
    v_mul_f32 v162, v22, v162
    v_mul_f32 v163, v22, v163
    v_mul_f32 v164, v22, v164
    v_mfma_f32_32x32x16_bf16 v[144:159], v[188:191], v[140:143], v[144:159]
    v_mul_f32 v165, v22, v165
    v_mul_f32 v166, v22, v166
    v_mul_f32 v167, v22, v167
    v_mul_f32 v168, v22, v168
    v_mul_f32 v169, v22, v169
    v_mul_f32 v170, v22, v170
    v_mul_f32 v171, v22, v171
    v_mul_f32 v172, v22, v172
    v_mul_f32 v173, v22, v173
    v_mul_f32 v174, v22, v174
    v_mul_f32 v175, v22, v175
    v_cvt_pk_bf16_f32 v200, v160, v161
    v_cvt_pk_bf16_f32 v201, v162, v163
    v_cvt_pk_bf16_f32 v202, v164, v165
    v_cvt_pk_bf16_f32 v203, v166, v167
    v_cvt_pk_bf16_f32 v204, v168, v169
    v_cvt_pk_bf16_f32 v205, v170, v171
    v_cvt_pk_bf16_f32 v192, v144, v145
    v_cvt_pk_bf16_f32 v193, v146, v147
    v_cvt_pk_bf16_f32 v194, v148, v149
    v_cvt_pk_bf16_f32 v195, v150, v151
    v_cvt_pk_bf16_f32 v196, v152, v153
    v_cvt_pk_bf16_f32 v197, v154, v155
    v_cvt_pk_bf16_f32 v198, v156, v157
    v_cvt_pk_bf16_f32 v199, v158, v159
    s_waitcnt lgkmcnt(0)
    v_mfma_f32_32x32x16_bf16 v[144:159], v[232:235], v[192:195], 0
    v_cvt_pk_bf16_f32 v206, v172, v173
    v_cvt_pk_bf16_f32 v207, v174, v175
    v_mov_b32 v2, 0x3f80
    v_cndmask_b32 v206, v206, v2, vcc
    v_cndmask_b32_e64 v207, v207, 0, vcc
    v_mfma_f32_32x32x16_bf16 v[144:159], v[236:239], v[196:199], v[144:159]
    v_bfe_u32 v2, v8, 1, 1
    v_xor_b32 v2, v2, v7
    v_lshlrev_b32 v2, 4, v2
    v_bfe_u32 v3, v8, 2, 1
    v_lshl_add_u32 v2, v3, 5, v2
    v_lshl_add_u32 v2, v8, 6, v2
    s_add_u32 s64, s69, 81920
    v_add_u32 v17, s64, v2
    v_xor_b32 v2, 32, v17
    ds_write_b128 v17, v[200:203]
    ds_write_b128 v2, v[204:207]
    v_and_b32 v2, 1, v8
    v_xor_b32 v2, v2, v7
    v_lshlrev_b32 v2, 4, v2
    v_bfe_u32 v3, v8, 1, 2
    v_lshl_add_u32 v2, v3, 5, v2
    v_lshl_add_u32 v2, v8, 7, v2
    s_add_u32 s64, s68, 65536
    v_add_u32 v10, s64, v2
    v_xor_b32 v11, 32, v10
    v_xor_b32 v12, 64, v10
    v_xor_b32 v13, 96, v10
    s_and_b32 s64, s9, 401408
    s_mov_b32 s36, s10
    s_mov_b32 s37, s11
    s_mov_b32 s38, s64
    s_mov_b32 s39, 0x20000
    v_lshrrev_b32 v2, 1, v1
    v_lshrrev_b32 v3, 4, v1
    v_xor_b32 v2, v2, v3
    v_and_b32 v2, 3, v2
    v_lshlrev_b32 v2, 5, v2
    v_and_b32 v3, 1, v1
    v_lshl_add_u32 v2, v3, 4, v2
    v_lshrrev_b32 v3, 3, v1
    v_mul_u32_u24 v3, 896, v3
    v_add_u32 v240, v3, v2
    v_max3_f32 v224, v144, v145, v146
    s_add_u32 m0, s69, 107520
    s_nop 0
    buffer_load_dwordx4 v244, s[32:35], s82 offen offset:0 lds
    v_min3_f32 v226, v144, v145, v146
    v_max3_f32 v224, v224, v147, v148
    v_min3_f32 v226, v226, v147, v148
    v_max3_f32 v224, v224, v149, v150
    v_min3_f32 v226, v226, v149, v150
    v_max3_f32 v224, v224, v151, v152
    v_min3_f32 v226, v226, v151, v152
    v_max3_f32 v224, v224, v153, v154
    v_min3_f32 v226, v226, v153, v154
    v_max3_f32 v224, v224, v155, v156
    v_min3_f32 v226, v226, v155, v156
    v_max_f32 v224, v224, v157
    v_min_f32 v226, v226, v157
    v_mul_f32 v224, v20, v224
    v_mul_f32_e64 v226, -v20, v226
    v_mov_b32 v215, 0
    v_mov_b32 v223, 0
    v_permlane32_swap_b32 v224, v226
    v_max_f32 v224, v224, v226
    v_mov_b32 v226, v224
    s_nop 1
    v_permlane32_swap_b32 v224, v226
    v_pk_fma_f32 v[160:161], v[144:145], v[20:21], v[224:225] op_sel_hi:[1,0,0] neg_lo:[0,0,1] neg_hi:[0,0,1]
    v_pk_fma_f32 v[176:177], v[144:145], v[20:21], v[226:227] op_sel_hi:[1,0,0] neg_lo:[1,0,1] neg_hi:[1,0,1]
    v_pk_fma_f32 v[162:163], v[146:147], v[20:21], v[224:225] op_sel_hi:[1,0,0] neg_lo:[0,0,1] neg_hi:[0,0,1]
    v_pk_fma_f32 v[178:179], v[146:147], v[20:21], v[226:227] op_sel_hi:[1,0,0] neg_lo:[1,0,1] neg_hi:[1,0,1]
    v_pk_fma_f32 v[164:165], v[148:149], v[20:21], v[224:225] op_sel_hi:[1,0,0] neg_lo:[0,0,1] neg_hi:[0,0,1]
    v_pk_fma_f32 v[180:181], v[148:149], v[20:21], v[226:227] op_sel_hi:[1,0,0] neg_lo:[1,0,1] neg_hi:[1,0,1]
    v_pk_fma_f32 v[166:167], v[150:151], v[20:21], v[224:225] op_sel_hi:[1,0,0] neg_lo:[0,0,1] neg_hi:[0,0,1]
    v_pk_fma_f32 v[182:183], v[150:151], v[20:21], v[226:227] op_sel_hi:[1,0,0] neg_lo:[1,0,1] neg_hi:[1,0,1]
    v_pk_fma_f32 v[168:169], v[152:153], v[20:21], v[224:225] op_sel_hi:[1,0,0] neg_lo:[0,0,1] neg_hi:[0,0,1]
    v_pk_fma_f32 v[184:185], v[152:153], v[20:21], v[226:227] op_sel_hi:[1,0,0] neg_lo:[1,0,1] neg_hi:[1,0,1]
    v_pk_fma_f32 v[170:171], v[154:155], v[20:21], v[224:225] op_sel_hi:[1,0,0] neg_lo:[0,0,1] neg_hi:[0,0,1]
    v_pk_fma_f32 v[186:187], v[154:155], v[20:21], v[226:227] op_sel_hi:[1,0,0] neg_lo:[1,0,1] neg_hi:[1,0,1]
    v_pk_fma_f32 v[172:173], v[156:157], v[20:21], v[224:225] op_sel_hi:[1,0,0] neg_lo:[0,0,1] neg_hi:[0,0,1]
    v_pk_fma_f32 v[188:189], v[156:157], v[20:21], v[226:227] op_sel_hi:[1,0,0] neg_lo:[1,0,1] neg_hi:[1,0,1]
    v_exp_f32 v160, v160
    v_exp_f32 v176, v176
    v_exp_f32 v161, v161
    v_exp_f32 v177, v177
    v_exp_f32 v162, v162
    v_exp_f32 v178, v178
    v_exp_f32 v163, v163
    v_exp_f32 v179, v179
    v_exp_f32 v164, v164
    v_exp_f32 v180, v180
    v_exp_f32 v165, v165
    v_exp_f32 v181, v181
    v_exp_f32 v166, v166
    v_exp_f32 v182, v182
    v_exp_f32 v167, v167
    v_exp_f32 v183, v183
    v_exp_f32 v168, v168
    v_exp_f32 v184, v184
    v_exp_f32 v169, v169
    v_exp_f32 v185, v185
    v_exp_f32 v170, v170
    v_exp_f32 v186, v186
    v_exp_f32 v171, v171
    v_exp_f32 v187, v187
    v_exp_f32 v172, v172
    s_add_u32 m0, s69, 114688
    s_nop 0
    buffer_load_dwordx4 v244, s[32:35], s83 offen offset:0 lds
    v_exp_f32 v188, v188
    v_exp_f32 v173, v173
    v_exp_f32 v189, v189
    v_pk_add_f32 v[224:225], v[160:161], v[162:163]
    v_pk_add_f32 v[226:227], v[176:177], v[178:179]
    v_pk_add_f32 v[224:225], v[224:225], v[164:165]
    v_pk_add_f32 v[226:227], v[226:227], v[180:181]
    v_pk_add_f32 v[224:225], v[224:225], v[166:167]
    v_pk_add_f32 v[226:227], v[226:227], v[182:183]
    v_pk_add_f32 v[224:225], v[224:225], v[168:169]
    v_pk_add_f32 v[226:227], v[226:227], v[184:185]
    v_pk_add_f32 v[224:225], v[224:225], v[170:171]
    v_pk_add_f32 v[226:227], v[226:227], v[186:187]
    v_pk_add_f32 v[224:225], v[224:225], v[172:173]
    v_pk_add_f32 v[226:227], v[226:227], v[188:189]
    v_add_f32 v224, v224, v225
    v_add_f32 v226, v226, v227
    s_nop 1
    v_permlane32_swap_b32 v224, v226
    v_add_f32 v224, v224, v226
    v_rcp_f32 v224, v224
    s_nop 0
    v_mov_b32 v226, v224
    s_nop 1
    v_permlane32_swap_b32 v224, v226
    v_pk_mul_f32 v[160:161], v[160:161], v[224:225] op_sel_hi:[1,0]
    v_pk_mul_f32 v[162:163], v[162:163], v[224:225] op_sel_hi:[1,0]
    v_pk_mul_f32 v[164:165], v[164:165], v[224:225] op_sel_hi:[1,0]
    v_pk_mul_f32 v[166:167], v[166:167], v[224:225] op_sel_hi:[1,0]
    v_pk_mul_f32 v[168:169], v[168:169], v[224:225] op_sel_hi:[1,0]
    v_pk_mul_f32 v[170:171], v[170:171], v[224:225] op_sel_hi:[1,0]
    v_pk_mul_f32 v[172:173], v[172:173], v[224:225] op_sel_hi:[1,0]
    v_cvt_pk_bf16_f32 v208, v160, v161
    v_cvt_pk_bf16_f32 v209, v162, v163
    v_cvt_pk_bf16_f32 v210, v164, v165
    v_cvt_pk_bf16_f32 v211, v166, v167
    v_cvt_pk_bf16_f32 v212, v168, v169
    v_cvt_pk_bf16_f32 v213, v170, v171
    v_cvt_pk_bf16_f32 v214, v172, v173
    ds_write_b128 v10, v[208:211]
    ds_write_b128 v11, v[212:215]
    v_pk_mul_f32 v[176:177], v[176:177], v[226:227] op_sel_hi:[1,0]
    v_pk_mul_f32 v[178:179], v[178:179], v[226:227] op_sel_hi:[1,0]
    v_pk_mul_f32 v[180:181], v[180:181], v[226:227] op_sel_hi:[1,0]
    v_pk_mul_f32 v[182:183], v[182:183], v[226:227] op_sel_hi:[1,0]
    v_pk_mul_f32 v[184:185], v[184:185], v[226:227] op_sel_hi:[1,0]
    v_pk_mul_f32 v[186:187], v[186:187], v[226:227] op_sel_hi:[1,0]
    v_pk_mul_f32 v[188:189], v[188:189], v[226:227] op_sel_hi:[1,0]
    v_cvt_pk_bf16_f32 v216, v176, v177
    v_cvt_pk_bf16_f32 v217, v178, v179
    v_cvt_pk_bf16_f32 v218, v180, v181
    v_cvt_pk_bf16_f32 v219, v182, v183
    v_cvt_pk_bf16_f32 v220, v184, v185
    v_cvt_pk_bf16_f32 v221, v186, v187
    v_cvt_pk_bf16_f32 v222, v188, v189
    ds_write_b128 v12, v[216:219]
    ds_write_b128 v13, v[220:223]
    v_lshrrev_b32 v2, 2, v1
    v_lshrrev_b32 v3, 1, v255
    v_lshlrev_b32 v3, 3, v3
    v_xor_b32 v16, v255, v2
    v_and_b32 v16, 1, v16
    v_lshl_add_u32 v16, v16, 4, v3
    v_bfe_u32 v17, v2, 1, 2
    v_xor_b32 v17, s52, v17
    v_lshl_add_u32 v16, v17, 5, v16
    v_lshl_add_u32 v16, v2, 7, v16
    v_add_u32 v16, 65536, v16
    v_lshrrev_b32 v18, 1, v2
    v_xor_b32 v18, v255, v18
    v_and_b32 v18, 1, v18
    v_lshl_add_u32 v18, v18, 4, v3
    v_bfe_u32 v17, v2, 2, 1
    v_lshl_add_u32 v18, v17, 5, v18
    v_lshl_add_u32 v18, v2, 6, v18
    v_add_u32 v18, 81920, v18
    v_xor_b32 v19, 32, v18
    s_add_u32 m0, s69, 115712
    s_nop 0
    buffer_load_dwordx4 v244, s[32:35], s84 offen offset:0 lds
    s_add_u32 m0, s69, 122880
    s_nop 0
    buffer_load_dwordx4 v244, s[32:35], s85 offen offset:0 lds
    s_lshl_b32 s64, s54, 2
    s_add_u32 s64, s64, s52
    s_lshl_b32 s69, s64, 14
    s_lshl_b32 s59, s53, 10
    s_add_u32 s59, s59, s69
    s_and_b32 s68, s53, 3
    s_lshl_b32 s68, s68, 12
    s_add_u32 s69, s69, s68
    s_lshl_b32 s68, s64, 9
    s_add_u32 s68, s68, 0xc00000
    s_lshl_b32 s60, s53, 5
    s_add_u32 s60, s60, s68
    s_waitcnt vmcnt(10)
    s_mov_b32 s67, 20000
L_tagw_3:
    v_readfirstlane_b32 s26, v252
    s_nop 0
    s_cmp_lg_u32 s26, 0
    s_nop 2
    s_cbranch_scc1 L_tagok_2
    s_sub_u32 s67, s67, 1
    s_cbranch_scc1 L_tagok_2
    s_mov_b32 s48, s22
    s_mov_b32 s49, s23
    s_mov_b32 s50, 0x100
    s_mov_b32 s51, 0x20000
    buffer_load_dword v252, off, s[48:51], 0 sc1
    s_waitcnt vmcnt(0)
    s_branch L_tagw_3
L_tagok_2:
    s_waitcnt lgkmcnt(0)
    s_barrier
    ds_read_b64_tr_b16 v[144:145], v16 offset:0
    ds_read_b64_tr_b16 v[146:147], v16 offset:2048
    ds_read_b64_tr_b16 v[160:161], v18 offset:0
    ds_read_b64_tr_b16 v[162:163], v18 offset:1024
    ds_read_b64_tr_b16 v[164:165], v19 offset:0
    ds_read_b64_tr_b16 v[166:167], v19 offset:1024
    ds_read_b64_tr_b16 v[148:149], v16 offset:4096
    ds_read_b64_tr_b16 v[150:151], v16 offset:6144
    ds_read_b64_tr_b16 v[168:169], v18 offset:2048
    ds_read_b64_tr_b16 v[170:171], v18 offset:3072
    ds_read_b64_tr_b16 v[172:173], v19 offset:2048
    ds_read_b64_tr_b16 v[174:175], v19 offset:3072
    ds_read_b64_tr_b16 v[152:153], v16 offset:8192
    ds_read_b64_tr_b16 v[154:155], v16 offset:10240
    ds_read_b64_tr_b16 v[176:177], v18 offset:4096
    ds_read_b64_tr_b16 v[178:179], v18 offset:5120
    ds_read_b64_tr_b16 v[180:181], v19 offset:4096
    ds_read_b64_tr_b16 v[182:183], v19 offset:5120
    ds_read_b64_tr_b16 v[156:157], v16 offset:12288
    ds_read_b64_tr_b16 v[158:159], v16 offset:14336
    ds_read_b64_tr_b16 v[184:185], v18 offset:6144
    ds_read_b64_tr_b16 v[186:187], v18 offset:7168
    ds_read_b64_tr_b16 v[188:189], v19 offset:6144
    ds_read_b64_tr_b16 v[190:191], v19 offset:7168
    s_waitcnt lgkmcnt(15)
    v_mfma_f32_16x16x32_bf16 v[192:195], v[144:147], v[160:163], 0
    v_mfma_f32_16x16x32_bf16 v[196:199], v[144:147], v[164:167], 0
    s_waitcnt lgkmcnt(12)
    v_mfma_f32_16x16x32_bf16 v[192:195], v[148:151], v[168:171], v[192:195]
    v_mfma_f32_16x16x32_bf16 v[196:199], v[148:151], v[172:175], v[196:199]
    s_waitcnt lgkmcnt(6)
    v_mfma_f32_16x16x32_bf16 v[192:195], v[152:155], v[176:179], v[192:195]
    v_mfma_f32_16x16x32_bf16 v[196:199], v[152:155], v[180:183], v[196:199]
    s_waitcnt lgkmcnt(0)
    v_mfma_f32_16x16x32_bf16 v[192:195], v[156:159], v[184:187], v[192:195]
    v_mfma_f32_16x16x32_bf16 v[196:199], v[156:159], v[188:191], v[196:199]
    s_nop 6
    v_cvt_pk_bf16_f32 v200, v192, v193
    v_cvt_pk_bf16_f32 v201, v194, v195
    v_cvt_pk_bf16_f32 v202, v196, v197
    v_cvt_pk_bf16_f32 v203, v198, v199
    buffer_store_dwordx4 v[200:203], v9, s[40:43], s59 offen sc1
    v_add_u32 v253, v200, v201
    v_add3_u32 v253, v202, v203, v253
    s_nop 1
    v_add_u32_dpp v253, v253, v253 row_ror:8 row_mask:0xf bank_mask:0xf
    s_nop 1
    v_add_u32_dpp v253, v253, v253 row_ror:4 row_mask:0xf bank_mask:0xf
    s_nop 1
    v_add_u32_dpp v253, v253, v253 row_ror:2 row_mask:0xf bank_mask:0xf
    s_nop 1
    v_add_u32_dpp v253, v253, v253 row_ror:1 row_mask:0xf bank_mask:0xf
    buffer_store_dwordx2 v[252:253], v0, s[40:43], s60 offen offset:0 sc1
    s_waitcnt vmcnt(2)
    s_barrier
    ds_read_b64_tr_b16 v[208:209], v14 offset:32768
    ds_read_b64_tr_b16 v[210:211], v14 offset:33024
    ds_read_b64_tr_b16 v[212:213], v14 offset:33792
    ds_read_b64_tr_b16 v[214:215], v14 offset:34048
    ds_read_b64_tr_b16 v[216:217], v14 offset:40960
    ds_read_b64_tr_b16 v[218:219], v14 offset:41216
    ds_read_b64_tr_b16 v[220:221], v14 offset:41984
    ds_read_b64_tr_b16 v[222:223], v14 offset:42240
    ds_read_b64_tr_b16 v[224:225], v14 offset:49152
    ds_read_b64_tr_b16 v[226:227], v14 offset:49408
    s_waitcnt lgkmcnt(8)
    v_mfma_f32_32x32x16_bf16 a[224:239], v[24:27], v[208:211], 0
    v_mfma_f32_32x32x16_bf16 v[144:159], v[208:211], v[32:35], 0
    s_waitcnt lgkmcnt(6)
    v_mfma_f32_32x32x16_bf16 a[224:239], v[24:27], v[212:215], a[224:239]
    v_accvgpr_read_b32 v22, a219
    s_mov_b32 s88, s16
    s_mov_b32 s89, s17
    s_mov_b32 s90, 0x188000
    s_mov_b32 s91, 0x20000
    s_mov_b32 s87, 0x7000
    buffer_load_dword a223, v22, s[88:91], s87 offen
    v_mfma_f32_32x32x16_bf16 v[144:159], v[212:215], v[48:51], v[144:159]
    ds_read_b64_tr_b16 v[228:229], v14 offset:50176
    ds_read_b64_tr_b16 v[230:231], v14 offset:50432
    s_waitcnt lgkmcnt(6)
    v_mfma_f32_32x32x16_bf16 a[224:239], v[24:27], v[216:219], a[224:239]
    v_mfma_f32_32x32x16_bf16 v[144:159], v[216:219], v[64:67], v[144:159]
    ds_read_b64_tr_b16 v[208:209], v14 offset:57344
    ds_read_b64_tr_b16 v[210:211], v14 offset:57600
    s_waitcnt lgkmcnt(6)
    v_mfma_f32_32x32x16_bf16 a[224:239], v[24:27], v[220:223], a[224:239]
    v_mfma_f32_32x32x16_bf16 v[144:159], v[220:223], v[80:83], v[144:159]
    ds_read_b64_tr_b16 v[212:213], v15 offset:32768
    ds_read_b64_tr_b16 v[214:215], v15 offset:33024
    s_waitcnt lgkmcnt(6)
    v_mfma_f32_32x32x16_bf16 a[224:239], v[24:27], v[224:227], a[224:239]
    v_mfma_f32_32x32x16_bf16 v[144:159], v[224:227], v[96:99], v[144:159]
    ds_read_b64_tr_b16 v[216:217], v15 offset:33792
    ds_read_b64_tr_b16 v[218:219], v15 offset:34048
    s_waitcnt lgkmcnt(6)
    v_mfma_f32_32x32x16_bf16 a[224:239], v[24:27], v[228:231], a[224:239]
    v_mfma_f32_32x32x16_bf16 v[144:159], v[228:231], v[112:115], v[144:159]
    ds_read_b64_tr_b16 v[220:221], v15 offset:40960
    ds_read_b64_tr_b16 v[222:223], v15 offset:41216
    s_waitcnt lgkmcnt(6)
    v_mfma_f32_32x32x16_bf16 a[224:239], v[24:27], v[208:211], a[224:239]
    s_mul_i32 s87, s52, 14336
    s_add_u32 m0, s87, 0
    s_add_u32 s87, s86, 0
    buffer_load_dwordx4 v240, s[36:39], s87 offen offset:0 lds
    v_mfma_f32_32x32x16_bf16 v[144:159], v[208:211], v[128:131], v[144:159]
    ds_read_b64_tr_b16 v[224:225], v15 offset:41984
    ds_read_b64_tr_b16 v[226:227], v15 offset:42240
    s_waitcnt lgkmcnt(6)
    v_mfma_f32_32x32x16_bf16 v[144:159], v[212:215], v[36:39], v[144:159]
    ds_read_b64_tr_b16 v[228:229], v15 offset:49152
    ds_read_b64_tr_b16 v[230:231], v15 offset:49408
    s_mul_i32 s87, s52, 14336
    s_add_u32 m0, s87, 1024
    s_add_u32 s87, s86, 7168
    buffer_load_dwordx4 v240, s[36:39], s87 offen offset:0 lds
    s_waitcnt lgkmcnt(6)
    v_mfma_f32_32x32x16_bf16 v[144:159], v[216:219], v[52:55], v[144:159]
    ds_read_b64_tr_b16 v[208:209], v15 offset:50176
    ds_read_b64_tr_b16 v[210:211], v15 offset:50432
    s_waitcnt lgkmcnt(6)
    v_mfma_f32_32x32x16_bf16 v[144:159], v[220:223], v[68:71], v[144:159]
    ds_read_b64_tr_b16 v[212:213], v15 offset:57344
    ds_read_b64_tr_b16 v[214:215], v15 offset:57600
    v_accvgpr_read_b32 v2, a224
    s_lshl_b32 s66, s52, 2
    v_lshlrev_b32 v196, 4, v8
    v_add_u32 v196, 125952, v196
    v_add_u32 v3, s66, v196
    ds_write_b32 v3, v2
    s_waitcnt lgkmcnt(7)
    v_mfma_f32_32x32x16_bf16 v[144:159], v[224:227], v[84:87], v[144:159]
    ds_read_b64_tr_b16 v[216:217], v21 offset:32768
    ds_read_b64_tr_b16 v[218:219], v21 offset:33024
    v_lshlrev_b32 v2, 3, v7
    v_sub_u32 v2, v8, v2
    v_mov_b32 v3, 0x3f80
    v_mov_b32 v16, 0x3f800000
    s_waitcnt lgkmcnt(7)
    v_mfma_f32_32x32x16_bf16 v[144:159], v[228:231], v[100:103], v[144:159]
    ds_read_b64_tr_b16 v[220:221], v21 offset:33792
    ds_read_b64_tr_b16 v[222:223], v21 offset:34048
    v_cmp_eq_u32 vcc, 0, v2
    s_nop 1
    v_cndmask_b32 v192, 0, v3, vcc
    v_cmp_eq_u32 vcc, 1, v2
    s_nop 1
    v_cndmask_b32 v192, v192, v16, vcc
    s_waitcnt lgkmcnt(7)
    v_mfma_f32_32x32x16_bf16 v[144:159], v[208:211], v[116:119], v[144:159]
    ds_read_b64_tr_b16 v[224:225], v21 offset:40960
    ds_read_b64_tr_b16 v[226:227], v21 offset:41216
    v_cmp_eq_u32 vcc, 2, v2
    s_nop 1
    v_cndmask_b32 v193, 0, v3, vcc
    v_cmp_eq_u32 vcc, 3, v2
    s_nop 1
    v_cndmask_b32 v193, v193, v16, vcc
    s_waitcnt lgkmcnt(7)
    v_mfma_f32_32x32x16_bf16 v[144:159], v[212:215], v[132:135], v[144:159]
    ds_read_b64_tr_b16 v[228:229], v21 offset:41984
    ds_read_b64_tr_b16 v[230:231], v21 offset:42240
    v_cmp_eq_u32 vcc, 4, v2
    s_nop 1
    v_cndmask_b32 v194, 0, v3, vcc
    v_cmp_eq_u32 vcc, 5, v2
    s_nop 1
    v_cndmask_b32 v194, v194, v16, vcc
    s_waitcnt lgkmcnt(6)
    v_mfma_f32_32x32x16_bf16 v[144:159], v[216:219], v[40:43], v[144:159]
    ds_read_b64_tr_b16 v[208:209], v21 offset:49152
    ds_read_b64_tr_b16 v[210:211], v21 offset:49408
    v_cmp_eq_u32 vcc, 6, v2
    s_nop 1
    v_cndmask_b32 v195, 0, v3, vcc
    v_cmp_eq_u32 vcc, 7, v2
    s_nop 1
    v_cndmask_b32 v195, v195, v16, vcc
    s_waitcnt lgkmcnt(6)
    v_mfma_f32_32x32x16_bf16 v[144:159], v[220:223], v[56:59], v[144:159]
    ds_read_b64_tr_b16 v[212:213], v21 offset:50176
    ds_read_b64_tr_b16 v[214:215], v21 offset:50432
    s_mul_i32 s87, s52, 14336
    s_add_u32 m0, s87, 2048
    s_add_u32 s87, s86, 14336
    buffer_load_dwordx4 v240, s[36:39], s87 offen offset:0 lds
    s_waitcnt lgkmcnt(6)
    v_mfma_f32_32x32x16_bf16 v[144:159], v[224:227], v[72:75], v[144:159]
    ds_read_b64_tr_b16 v[216:217], v21 offset:57344
    ds_read_b64_tr_b16 v[218:219], v21 offset:57600
    s_waitcnt lgkmcnt(6)
    v_mfma_f32_32x32x16_bf16 v[144:159], v[228:231], v[88:91], v[144:159]
    ds_read_b64_tr_b16 v[220:221], v23 offset:32768
    ds_read_b64_tr_b16 v[222:223], v23 offset:33024
    s_mul_i32 s87, s52, 14336
    s_add_u32 m0, s87, 3072
    s_add_u32 s87, s86, 21504
    buffer_load_dwordx4 v240, s[36:39], s87 offen offset:0 lds
    s_waitcnt lgkmcnt(6)
    v_mfma_f32_32x32x16_bf16 v[144:159], v[208:211], v[104:107], v[144:159]
    ds_read_b64_tr_b16 v[224:225], v23 offset:33792
    ds_read_b64_tr_b16 v[226:227], v23 offset:34048
    s_mul_i32 s87, s52, 14336
    s_add_u32 m0, s87, 4096
    s_add_u32 s87, s86, 28672
    buffer_load_dwordx4 v240, s[36:39], s87 offen offset:0 lds
    s_waitcnt lgkmcnt(6)
    v_mfma_f32_32x32x16_bf16 v[144:159], v[212:215], v[120:123], v[144:159]
    ds_read_b64_tr_b16 v[228:229], v23 offset:40960
    ds_read_b64_tr_b16 v[230:231], v23 offset:41216
    s_mul_i32 s87, s52, 14336
    s_add_u32 m0, s87, 5120
    s_add_u32 s87, s86, 35840
    buffer_load_dwordx4 v240, s[36:39], s87 offen offset:0 lds
    s_waitcnt lgkmcnt(6)
    v_mfma_f32_32x32x16_bf16 v[144:159], v[216:219], v[136:139], v[144:159]
    ds_read_b64_tr_b16 v[208:209], v23 offset:41984
    ds_read_b64_tr_b16 v[210:211], v23 offset:42240
    s_mul_i32 s87, s52, 14336
    s_add_u32 m0, s87, 6144
    s_add_u32 s87, s86, 43008
    buffer_load_dwordx4 v240, s[36:39], s87 offen offset:0 lds
    s_waitcnt lgkmcnt(6)
    v_mfma_f32_32x32x16_bf16 v[144:159], v[220:223], v[44:47], v[144:159]
    ds_read_b64_tr_b16 v[212:213], v23 offset:49152
    ds_read_b64_tr_b16 v[214:215], v23 offset:49408
    s_mul_i32 s87, s52, 14336
    s_add_u32 m0, s87, 7168
    s_add_u32 s87, s86, 50176
    buffer_load_dwordx4 v240, s[36:39], s87 offen offset:0 lds
    s_waitcnt lgkmcnt(6)
    v_mfma_f32_32x32x16_bf16 v[144:159], v[224:227], v[60:63], v[144:159]
    ds_read_b64_tr_b16 v[216:217], v23 offset:50176
    ds_read_b64_tr_b16 v[218:219], v23 offset:50432
    ds_read_b64_tr_b16 v[220:221], v23 offset:57344
    ds_read_b64_tr_b16 v[222:223], v23 offset:57600
    s_mul_i32 s87, s52, 14336
    s_add_u32 m0, s87, 8192
    s_add_u32 s87, s86, 57344
    buffer_load_dwordx4 v240, s[36:39], s87 offen offset:0 lds
    s_waitcnt lgkmcnt(8)
    v_mfma_f32_32x32x16_bf16 v[144:159], v[228:231], v[76:79], v[144:159]
    s_mul_i32 s87, s52, 14336
    s_add_u32 m0, s87, 9216
    s_add_u32 s87, s86, 64512
    buffer_load_dwordx4 v240, s[36:39], s87 offen offset:0 lds
    s_waitcnt lgkmcnt(6)
    v_mfma_f32_32x32x16_bf16 v[144:159], v[208:211], v[92:95], v[144:159]
    s_waitcnt lgkmcnt(0)
    s_barrier
    ds_read_b128 v[196:199], v196
    v_cmp_gt_u32 vcc, 32, v1
    s_waitcnt lgkmcnt(5)
    v_mfma_f32_32x32x16_bf16 v[144:159], v[212:215], v[108:111], v[144:159]
    s_mul_i32 s87, s52, 14336
    s_add_u32 m0, s87, 10240
    s_add_u32 s87, s86, 71680
    buffer_load_dwordx4 v240, s[36:39], s87 offen offset:0 lds
    s_waitcnt lgkmcnt(3)
    v_mfma_f32_32x32x16_bf16 v[144:159], v[216:219], v[124:127], v[144:159]
    s_waitcnt lgkmcnt(0)
    v_add_f32 v196, v196, v197
    v_add_f32 v198, v198, v199
    v_mov_b32 v202, 0
    v_add_f32 v196, v196, v198
    v_mov_b32 v203, 0
    s_waitcnt lgkmcnt(1)
    v_mfma_f32_32x32x16_bf16 v[144:159], v[220:223], v[140:143], v[144:159]
    v_cndmask_b32 v196, 0, v196, vcc
    v_cvt_pk_bf16_f32 v201, v196, 0
    v_lshlrev_b32 v2, 16, v201
    v_sub_f32 v2, v196, v2
    v_cvt_pk_bf16_f32 v200, v196, v2
    s_nop 1
    v_mfma_f32_32x32x16_bf16 v[144:159], v[200:203], v[28:31], v[144:159]
    s_nop 11
    v_cvt_pk_bf16_f32 v160, v144, v145
    v_cvt_pk_bf16_f32 v161, v146, v147
    v_cvt_pk_bf16_f32 v162, v148, v149
    v_cvt_pk_bf16_f32 v163, v150, v151
    v_cvt_pk_bf16_f32 v164, v152, v153
    v_cvt_pk_bf16_f32 v165, v154, v155
    v_cvt_pk_bf16_f32 v166, v156, v157
    v_cvt_pk_bf16_f32 v167, v158, v159
    v_mfma_f32_32x32x16_bf16 v[144:159], v[232:235], v[160:163], 0
    s_nop 0
    v_mfma_f32_32x32x16_bf16 v[144:159], v[236:239], v[164:167], v[144:159]
    s_bfe_u32 s66, s69, 0x2000c
    s_lshl_b32 s66, s66, 7
    v_xor_b32 v15, s66, v250
    s_mul_i32 s87, s52, 14336
    s_add_u32 m0, s87, 11264
    s_add_u32 s87, s86, 78848
    buffer_load_dwordx4 v240, s[36:39], s87 offen offset:0 lds
    s_mul_i32 s87, s52, 14336
    s_add_u32 m0, s87, 12288
    s_add_u32 s87, s86, 86016
    buffer_load_dwordx4 v240, s[36:39], s87 offen offset:0 lds
    v_and_b32 v3, 15, v1
    v_bfe_u32 v2, v1, 4, 1
    v_lshlrev_b32 v2, 9, v2
    v_lshl_add_u32 v2, v7, 8, v2
    v_lshl_add_u32 v2, v3, 4, v2
    s_lshl_b32 s66, s52, 10
    s_add_u32 s66, s66, 114688
    v_add_u32 v10, s66, v2
    v_add_u32 v12, 114688, v9
    s_mul_i32 s87, s52, 14336
    s_add_u32 m0, s87, 13312
    s_add_u32 s87, s86, 93184
    buffer_load_dwordx4 v240, s[36:39], s87 offen offset:0 lds
    v_bfe_u32 v2, v1, 4, 1
    v_lshlrev_b32 v13, 8, v2
    v_lshl_add_u32 v13, v7, 3, v13
    v_lshlrev_b32 v2, 14, v2
    v_lshl_add_u32 v2, v7, 8, v2
    v_lshl_add_u32 v11, v3, 4, v2
    v_max3_f32 v224, v144, v145, v146
    v_min3_f32 v226, v144, v145, v146
    v_max3_f32 v224, v224, v147, v148
    v_min3_f32 v226, v226, v147, v148
    v_max3_f32 v224, v224, v149, v150
    v_min3_f32 v226, v226, v149, v150
    v_max3_f32 v224, v224, v151, v152
    v_min3_f32 v226, v226, v151, v152
    v_max3_f32 v224, v224, v153, v154
    v_min3_f32 v226, v226, v153, v154
    v_max3_f32 v224, v224, v155, v156
    v_min3_f32 v226, v226, v155, v156
    v_max_f32 v224, v224, v157
    v_min_f32 v226, v226, v157
    v_mul_f32 v224, v20, v224
    v_mul_f32_e64 v226, -v20, v226
    v_mov_b32 v215, 0
    v_mov_b32 v223, 0
    v_permlane32_swap_b32 v224, v226
    v_max_f32 v224, v224, v226
    v_mov_b32 v226, v224
    s_nop 1
    v_permlane32_swap_b32 v224, v226
    v_pk_fma_f32 v[160:161], v[144:145], v[20:21], v[224:225] op_sel_hi:[1,0,0] neg_lo:[0,0,1] neg_hi:[0,0,1]
    v_pk_fma_f32 v[176:177], v[144:145], v[20:21], v[226:227] op_sel_hi:[1,0,0] neg_lo:[1,0,1] neg_hi:[1,0,1]
    v_pk_fma_f32 v[162:163], v[146:147], v[20:21], v[224:225] op_sel_hi:[1,0,0] neg_lo:[0,0,1] neg_hi:[0,0,1]
    v_pk_fma_f32 v[178:179], v[146:147], v[20:21], v[226:227] op_sel_hi:[1,0,0] neg_lo:[1,0,1] neg_hi:[1,0,1]
    v_pk_fma_f32 v[164:165], v[148:149], v[20:21], v[224:225] op_sel_hi:[1,0,0] neg_lo:[0,0,1] neg_hi:[0,0,1]
    v_pk_fma_f32 v[180:181], v[148:149], v[20:21], v[226:227] op_sel_hi:[1,0,0] neg_lo:[1,0,1] neg_hi:[1,0,1]
    v_pk_fma_f32 v[166:167], v[150:151], v[20:21], v[224:225] op_sel_hi:[1,0,0] neg_lo:[0,0,1] neg_hi:[0,0,1]
    v_pk_fma_f32 v[182:183], v[150:151], v[20:21], v[226:227] op_sel_hi:[1,0,0] neg_lo:[1,0,1] neg_hi:[1,0,1]
    v_pk_fma_f32 v[168:169], v[152:153], v[20:21], v[224:225] op_sel_hi:[1,0,0] neg_lo:[0,0,1] neg_hi:[0,0,1]
    v_pk_fma_f32 v[184:185], v[152:153], v[20:21], v[226:227] op_sel_hi:[1,0,0] neg_lo:[1,0,1] neg_hi:[1,0,1]
    v_pk_fma_f32 v[170:171], v[154:155], v[20:21], v[224:225] op_sel_hi:[1,0,0] neg_lo:[0,0,1] neg_hi:[0,0,1]
    v_pk_fma_f32 v[186:187], v[154:155], v[20:21], v[226:227] op_sel_hi:[1,0,0] neg_lo:[1,0,1] neg_hi:[1,0,1]
    v_pk_fma_f32 v[172:173], v[156:157], v[20:21], v[224:225] op_sel_hi:[1,0,0] neg_lo:[0,0,1] neg_hi:[0,0,1]
    v_pk_fma_f32 v[188:189], v[156:157], v[20:21], v[226:227] op_sel_hi:[1,0,0] neg_lo:[1,0,1] neg_hi:[1,0,1]
    v_exp_f32 v160, v160
    buffer_load_dwordx2 v[248:249], v15, s[40:43], s68 offen sc1
    v_exp_f32 v176, v176
    v_exp_f32 v161, v161
    v_exp_f32 v177, v177
    v_exp_f32 v162, v162
    v_exp_f32 v178, v178
    v_exp_f32 v163, v163
    s_xor_b32 s59, s69, 0
    buffer_load_dwordx4 v[32:35], v9, s[40:43], s59 offen offset:0 sc1
    v_exp_f32 v179, v179
    v_exp_f32 v164, v164
    v_exp_f32 v180, v180
    v_exp_f32 v165, v165
    v_exp_f32 v181, v181
    v_exp_f32 v166, v166
    buffer_load_dwordx4 v[36:39], v9, s[40:43], s59 offen offset:1024 sc1
    v_exp_f32 v182, v182
    v_exp_f32 v167, v167
    v_exp_f32 v183, v183
    v_exp_f32 v168, v168
    v_exp_f32 v184, v184
    v_exp_f32 v169, v169
    buffer_load_dwordx4 v[40:43], v9, s[40:43], s59 offen offset:2048 sc1
    v_exp_f32 v185, v185
    v_exp_f32 v170, v170
    v_exp_f32 v186, v186
    v_exp_f32 v171, v171
    v_exp_f32 v187, v187
    v_exp_f32 v172, v172
    buffer_load_dwordx4 v[44:47], v9, s[40:43], s59 offen offset:3072 sc1
    v_exp_f32 v188, v188
    v_exp_f32 v173, v173
    v_exp_f32 v189, v189
    v_pk_add_f32 v[224:225], v[160:161], v[162:163]
    v_pk_add_f32 v[226:227], v[176:177], v[178:179]
    v_pk_add_f32 v[224:225], v[224:225], v[164:165]
    v_pk_add_f32 v[226:227], v[226:227], v[180:181]
    v_pk_add_f32 v[224:225], v[224:225], v[166:167]
    v_pk_add_f32 v[226:227], v[226:227], v[182:183]
    s_xor_b32 s59, s69, 4096
    buffer_load_dwordx4 v[48:51], v9, s[40:43], s59 offen offset:0 sc1
    v_pk_add_f32 v[224:225], v[224:225], v[168:169]
    v_pk_add_f32 v[226:227], v[226:227], v[184:185]
    v_pk_add_f32 v[224:225], v[224:225], v[170:171]
    v_pk_add_f32 v[226:227], v[226:227], v[186:187]
    v_pk_add_f32 v[224:225], v[224:225], v[172:173]
    v_pk_add_f32 v[226:227], v[226:227], v[188:189]
    v_add_f32 v224, v224, v225
    v_add_f32 v226, v226, v227
    s_nop 1
    v_permlane32_swap_b32 v224, v226
    v_add_f32 v224, v224, v226
    v_rcp_f32 v224, v224
    buffer_load_dwordx4 v[52:55], v9, s[40:43], s59 offen offset:1024 sc1
    v_mov_b32 v226, v224
    s_nop 1
    v_permlane32_swap_b32 v224, v226
    v_pk_mul_f32 v[160:161], v[160:161], v[224:225] op_sel_hi:[1,0]
    v_pk_mul_f32 v[162:163], v[162:163], v[224:225] op_sel_hi:[1,0]
    v_pk_mul_f32 v[164:165], v[164:165], v[224:225] op_sel_hi:[1,0]
    v_pk_mul_f32 v[166:167], v[166:167], v[224:225] op_sel_hi:[1,0]
    v_pk_mul_f32 v[168:169], v[168:169], v[224:225] op_sel_hi:[1,0]
    v_pk_mul_f32 v[170:171], v[170:171], v[224:225] op_sel_hi:[1,0]
    v_pk_mul_f32 v[172:173], v[172:173], v[224:225] op_sel_hi:[1,0]
    v_cvt_pk_bf16_f32 v208, v160, v161
    v_cvt_pk_bf16_f32 v209, v162, v163
    v_cvt_pk_bf16_f32 v210, v164, v165
    buffer_load_dwordx4 v[56:59], v9, s[40:43], s59 offen offset:2048 sc1
    v_cvt_pk_bf16_f32 v211, v166, v167
    v_cvt_pk_bf16_f32 v212, v168, v169
    v_cvt_pk_bf16_f32 v213, v170, v171
    v_cvt_pk_bf16_f32 v214, v172, v173
    v_pk_mul_f32 v[176:177], v[176:177], v[226:227] op_sel_hi:[1,0]
    v_pk_mul_f32 v[178:179], v[178:179], v[226:227] op_sel_hi:[1,0]
    v_pk_mul_f32 v[180:181], v[180:181], v[226:227] op_sel_hi:[1,0]
    v_pk_mul_f32 v[182:183], v[182:183], v[226:227] op_sel_hi:[1,0]
    v_pk_mul_f32 v[184:185], v[184:185], v[226:227] op_sel_hi:[1,0]
    v_pk_mul_f32 v[186:187], v[186:187], v[226:227] op_sel_hi:[1,0]
    v_pk_mul_f32 v[188:189], v[188:189], v[226:227] op_sel_hi:[1,0]
    v_cvt_pk_bf16_f32 v216, v176, v177
    buffer_load_dwordx4 v[60:63], v9, s[40:43], s59 offen offset:3072 sc1
    v_cvt_pk_bf16_f32 v217, v178, v179
    v_cvt_pk_bf16_f32 v218, v180, v181
    v_cvt_pk_bf16_f32 v219, v182, v183
    v_cvt_pk_bf16_f32 v220, v184, v185
    v_cvt_pk_bf16_f32 v221, v186, v187
    v_cvt_pk_bf16_f32 v222, v188, v189
    s_xor_b32 s59, s69, 8192
    buffer_load_dwordx4 v[64:67], v9, s[40:43], s59 offen offset:0 sc1
    buffer_load_dwordx4 v[68:71], v9, s[40:43], s59 offen offset:1024 sc1
    buffer_load_dwordx4 v[72:75], v9, s[40:43], s59 offen offset:2048 sc1
    buffer_load_dwordx4 v[76:79], v9, s[40:43], s59 offen offset:3072 sc1
    s_xor_b32 s59, s69, 12288
    buffer_load_dwordx4 v[80:83], v9, s[40:43], s59 offen offset:0 sc1
    buffer_load_dwordx4 v[84:87], v9, s[40:43], s59 offen offset:1024 sc1
    buffer_load_dwordx4 v[88:91], v9, s[40:43], s59 offen offset:2048 sc1
    buffer_load_dwordx4 v[92:95], v9, s[40:43], s59 offen offset:3072 sc1
    s_and_b32 s64, s9, 1605632
    s_mov_b32 s32, s12
    s_mov_b32 s33, s13
    s_mov_b32 s34, s64
    s_mov_b32 s35, 0x20000
    v_lshrrev_b32 v2, 2, v1
    v_lshrrev_b32 v3, 4, v1
    v_xor_b32 v2, v2, v3
    v_and_b32 v2, 1, v2
    v_lshlrev_b32 v2, 6, v2
    v_lshl_add_u32 v2, v255, 4, v2
    v_lshrrev_b32 v3, 3, v1
    v_mul_u32_u24 v3, 3584, v3
    v_add_u32 v20, v3, v2
    s_mul_i32 s8, s52, 57344
    s_lshl_b32 s64, s56, 8
    s_add_u32 s8, s8, s64
    s_mul_i32 s87, s72, 56
    s_add_u32 m0, s7, 0
    s_add_u32 s87, s87, s27
    buffer_load_dwordx4 v4, s[44:47], s87 offen offset:0 lds
    s_add_u32 s87, s87, 7168
    s_add_u32 m0, m0, 1024
    s_nop 0
    buffer_load_dwordx4 v4, s[44:47], s87 offen offset:0 lds
    s_mul_i32 s87, s73, 56
    s_add_u32 m0, s7, 2048
    s_add_u32 s87, s87, s27
    buffer_load_dwordx4 v4, s[44:47], s87 offen offset:0 lds
    s_add_u32 s87, s87, 7168
    s_add_u32 m0, m0, 1024
    s_nop 0
    buffer_load_dwordx4 v4, s[44:47], s87 offen offset:0 lds
    s_mul_i32 s87, s74, 56
    s_add_u32 m0, s7, 4096
    s_add_u32 s87, s87, s27
    buffer_load_dwordx4 v4, s[44:47], s87 offen offset:0 lds
    s_add_u32 s87, s87, 7168
    s_add_u32 m0, m0, 1024
    s_nop 0
    buffer_load_dwordx4 v4, s[44:47], s87 offen offset:0 lds
    s_mul_i32 s87, s75, 56
    s_add_u32 m0, s7, 6144
    s_add_u32 s87, s87, s27
    buffer_load_dwordx4 v4, s[44:47], s87 offen offset:0 lds
    s_add_u32 s87, s87, 7168
    s_add_u32 m0, m0, 1024
    s_nop 0
    buffer_load_dwordx4 v4, s[44:47], s87 offen offset:0 lds
    s_waitcnt vmcnt(24)
    v_cmp_ne_u32 vcc, s26, v248
    s_nop 4
    s_cbranch_vccnz L_again
L_allp:
    s_waitcnt vmcnt(23)
    v_mfma_f32_32x32x16_bf16 v[100:115], v[192:195], v[32:35], 0
    v_add_u32 v14, v32, v33
    v_add3_u32 v14, v34, v35, v14
    s_waitcnt vmcnt(22)
    v_mfma_f32_32x32x16_bf16 v[100:115], v[192:195], v[36:39], v[100:115]
    v_add3_u32 v14, v36, v37, v14
    v_add3_u32 v14, v38, v39, v14
    s_waitcnt vmcnt(21)
    v_mfma_f32_32x32x16_bf16 v[100:115], v[192:195], v[40:43], v[100:115]
    v_add3_u32 v14, v40, v41, v14
    v_add3_u32 v14, v42, v43, v14
    s_waitcnt vmcnt(20)
    v_mfma_f32_32x32x16_bf16 v[100:115], v[192:195], v[44:47], v[100:115]
    v_add3_u32 v14, v44, v45, v14
    v_add3_u32 v14, v46, v47, v14
    s_waitcnt vmcnt(19)
    v_mfma_f32_32x32x16_bf16 v[100:115], v[192:195], v[48:51], v[100:115]
    v_add3_u32 v14, v48, v49, v14
    v_add3_u32 v14, v50, v51, v14
    s_waitcnt vmcnt(18)
    v_mfma_f32_32x32x16_bf16 v[100:115], v[192:195], v[52:55], v[100:115]
    v_add3_u32 v14, v52, v53, v14
    v_add3_u32 v14, v54, v55, v14
    s_waitcnt vmcnt(17)
    v_mfma_f32_32x32x16_bf16 v[100:115], v[192:195], v[56:59], v[100:115]
    v_add3_u32 v14, v56, v57, v14
    v_add3_u32 v14, v58, v59, v14
    s_waitcnt vmcnt(16)
    v_mfma_f32_32x32x16_bf16 v[100:115], v[192:195], v[60:63], v[100:115]
    v_add3_u32 v14, v60, v61, v14
    v_add3_u32 v14, v62, v63, v14
    s_waitcnt vmcnt(15)
    v_mfma_f32_32x32x16_bf16 v[100:115], v[192:195], v[64:67], v[100:115]
    v_add3_u32 v14, v64, v65, v14
    v_add3_u32 v14, v66, v67, v14
    s_waitcnt vmcnt(14)
    v_mfma_f32_32x32x16_bf16 v[100:115], v[192:195], v[68:71], v[100:115]
    v_add3_u32 v14, v68, v69, v14
    v_add3_u32 v14, v70, v71, v14
    s_waitcnt vmcnt(13)
    v_mfma_f32_32x32x16_bf16 v[100:115], v[192:195], v[72:75], v[100:115]
    v_add3_u32 v14, v72, v73, v14
    v_add3_u32 v14, v74, v75, v14
    s_waitcnt vmcnt(12)
    v_mfma_f32_32x32x16_bf16 v[100:115], v[192:195], v[76:79], v[100:115]
    v_add3_u32 v14, v76, v77, v14
    v_add3_u32 v14, v78, v79, v14
    s_waitcnt vmcnt(11)
    v_mfma_f32_32x32x16_bf16 v[100:115], v[192:195], v[80:83], v[100:115]
    v_add3_u32 v14, v80, v81, v14
    v_add3_u32 v14, v82, v83, v14
    s_waitcnt vmcnt(10)
    v_mfma_f32_32x32x16_bf16 v[100:115], v[192:195], v[84:87], v[100:115]
    v_add3_u32 v14, v84, v85, v14
    v_add3_u32 v14, v86, v87, v14
    s_waitcnt vmcnt(9)
    v_mfma_f32_32x32x16_bf16 v[100:115], v[192:195], v[88:91], v[100:115]
    v_add3_u32 v14, v88, v89, v14
    v_add3_u32 v14, v90, v91, v14
    s_waitcnt vmcnt(8)
    v_mfma_f32_32x32x16_bf16 v[100:115], v[192:195], v[92:95], v[100:115]
    v_add3_u32 v14, v92, v93, v14
    v_add3_u32 v14, v94, v95, v14
    s_nop 9
L_cont_b:
    v_sub_u32 v3, v14, v249
    s_lshl_b32 s60, s53, 2
    s_add_u32 s60, s60, s52
    v_add_u32_dpp v3, v3, v3 row_ror:8 row_mask:0xf bank_mask:0xf
    s_lshl_b32 s59, s60, 15
    s_lshl_b32 s57, s54, 10
    v_add_u32_dpp v3, v3, v3 row_ror:4 row_mask:0xf bank_mask:0xf
    s_add_u32 s59, s59, s57
    s_add_u32 s59, s59, 0x100000
    v_add_u32_dpp v3, v3, v3 row_ror:2 row_mask:0xf bank_mask:0xf
    s_lshl_b32 s60, s60, 9
    s_lshl_b32 s57, s54, 4
    v_add_u32_dpp v3, v3, v3 row_ror:1 row_mask:0xf bank_mask:0xf
    s_add_u32 s60, s60, s57
    s_add_u32 s60, s60, 0xc10000
    v_cvt_pk_bf16_f32 v116, v100, v101
    v_cvt_pk_bf16_f32 v117, v102, v103
    v_cvt_pk_bf16_f32 v118, v104, v105
    v_cvt_pk_bf16_f32 v119, v106, v107
    ds_write_b128 v10, v[116:119]
    v_readlane_b32 s64, v3, 0
    v_readlane_b32 s65, v3, 16
    v_readlane_b32 s66, v3, 32
    v_readlane_b32 s67, v3, 48
    s_add_u32 s64, s64, s65
    s_add_u32 s66, s66, s67
    s_add_u32 s64, s64, s66
    s_cmp_eq_u32 s64, 0
    s_nop 0
    s_cbranch_scc1 L_vok_4
    s_sub_u32 s3, s3, 1
    s_cbranch_scc0 L_slow_b2
L_vok_4:
    s_waitcnt lgkmcnt(0)
    s_barrier
    ds_read_b128 v[116:119], v12 offset:0
    ds_read_b128 v[120:123], v12 offset:1024
    ds_read_b128 v[124:127], v12 offset:2048
    ds_read_b128 v[128:131], v12 offset:3072
    s_waitcnt lgkmcnt(3)
    v_mfma_f32_32x32x16_bf16 v[144:159], v[116:119], v[208:211], 0
    s_waitcnt lgkmcnt(2)
    v_mfma_f32_32x32x16_bf16 v[144:159], v[120:123], v[212:215], v[144:159]
    s_waitcnt lgkmcnt(1)
    v_mfma_f32_32x32x16_bf16 v[144:159], v[124:127], v[216:219], v[144:159]
    s_waitcnt lgkmcnt(0)
    v_mfma_f32_32x32x16_bf16 v[144:159], v[128:131], v[220:223], v[144:159]
    v_cmp_gt_u32 vcc, 32, v1
    s_nop 10
    v_mov_b32 v16, v156
    v_mov_b32 v18, v156
    s_nop 1
    v_permlane32_swap_b32 v16, v18
    v_add_f32 v16, 0x358637bd, v16
    v_rcp_f32 v16, v16
    v_cndmask_b32_e64 v156, v156, 0, vcc
    v_pk_mul_f32 v[144:145], v[144:145], v[16:17] op_sel_hi:[1,0]
    v_pk_mul_f32 v[146:147], v[146:147], v[16:17] op_sel_hi:[1,0]
    v_pk_mul_f32 v[148:149], v[148:149], v[16:17] op_sel_hi:[1,0]
    v_pk_mul_f32 v[150:151], v[150:151], v[16:17] op_sel_hi:[1,0]
    v_cvt_pk_bf16_f32 v160, v144, v145
    v_cvt_pk_bf16_f32 v161, v146, v147
    v_cvt_pk_bf16_f32 v162, v148, v149
    v_cvt_pk_bf16_f32 v163, v150, v151
    buffer_store_dwordx4 v[160:163], v11, s[40:43], s59 offen offset:0 sc1
    v_pk_mul_f32 v[152:153], v[152:153], v[16:17] op_sel_hi:[1,0]
    v_pk_mul_f32 v[154:155], v[154:155], v[16:17] op_sel_hi:[1,0]
    v_pk_mul_f32 v[156:157], v[156:157], v[16:17] op_sel_hi:[1,0]
    v_pk_mul_f32 v[158:159], v[158:159], v[16:17] op_sel_hi:[1,0]
    v_cvt_pk_bf16_f32 v164, v152, v153
    v_cvt_pk_bf16_f32 v165, v154, v155
    v_cvt_pk_bf16_f32 v166, v156, v157
    v_cvt_pk_bf16_f32 v167, v158, v159
    buffer_store_dwordx4 v[164:167], v11, s[40:43], s59 offen offset:512 sc1
    v_add_u32 v253, v160, v161
    v_add3_u32 v253, v162, v163, v253
    v_add3_u32 v253, v164, v165, v253
    v_add3_u32 v253, v166, v167, v253
    s_nop 1
    v_add_u32_dpp v253, v253, v253 row_ror:8 row_mask:0xf bank_mask:0xf
    s_nop 1
    v_add_u32_dpp v253, v253, v253 row_ror:4 row_mask:0xf bank_mask:0xf
    s_nop 1
    v_add_u32_dpp v253, v253, v253 row_ror:2 row_mask:0xf bank_mask:0xf
    s_nop 1
    v_add_u32_dpp v253, v253, v253 row_ror:1 row_mask:0xf bank_mask:0xf
    buffer_store_dwordx2 v[252:253], v13, s[40:43], s60 offen offset:0 sc1
    s_cmp_ge_u32 s56, 14
    s_nop 2
    s_cbranch_scc1 L_spare
    v_and_b32 v22, 15, v1
    s_lshl1_add_u32 s87, s6, s52
    v_mul_u32_u24 v22, 896, v22
    s_mul_i32 s87, s87, 14336
    v_add_u32 v22, v22, v0
    s_add_u32 s87, s87, s4
    buffer_load_dwordx2 v[240:241], v22, s[28:31], s87 offen offset:0
    buffer_load_dwordx2 v[242:243], v22, s[28:31], s87 offen offset:32
    buffer_load_dwordx2 v[244:245], v22, s[28:31], s87 offen offset:64
    buffer_load_dwordx2 v[246:247], v22, s[28:31], s87 offen offset:96
    s_waitcnt vmcnt(13)
    ds_read_b64_tr_b16 a[0:1], v5 offset:0
    ds_read_b64_tr_b16 a[2:3], v5 offset:1024
    ds_read_b64_tr_b16 a[4:5], v6 offset:0
    ds_read_b64_tr_b16 a[6:7], v6 offset:1024
    s_waitcnt vmcnt(11)
    ds_read_b64_tr_b16 a[8:9], v5 offset:2048
    ds_read_b64_tr_b16 a[10:11], v5 offset:3072
    ds_read_b64_tr_b16 a[12:13], v6 offset:2048
    ds_read_b64_tr_b16 a[14:15], v6 offset:3072
    s_waitcnt vmcnt(9)
    ds_read_b64_tr_b16 a[16:17], v5 offset:4096
    ds_read_b64_tr_b16 a[18:19], v5 offset:5120
    ds_read_b64_tr_b16 a[20:21], v6 offset:4096
    ds_read_b64_tr_b16 a[22:23], v6 offset:5120
    s_waitcnt vmcnt(7)
    ds_read_b64_tr_b16 a[24:25], v5 offset:6144
    ds_read_b64_tr_b16 a[26:27], v5 offset:7168
    ds_read_b64_tr_b16 a[28:29], v6 offset:6144
    ds_read_b64_tr_b16 a[30:31], v6 offset:7168
    s_waitcnt lgkmcnt(12)
    s_mul_i32 s87, s76, 56
    s_add_u32 m0, s7, 0
    s_add_u32 s87, s87, s27
    buffer_load_dwordx4 v4, s[44:47], s87 offen offset:0 lds
    s_add_u32 s87, s87, 7168
    s_add_u32 m0, m0, 1024
    s_nop 0
    buffer_load_dwordx4 v4, s[44:47], s87 offen offset:0 lds
    s_waitcnt lgkmcnt(8)
    s_mul_i32 s87, s77, 56
    s_add_u32 m0, s7, 2048
    s_add_u32 s87, s87, s27
    buffer_load_dwordx4 v4, s[44:47], s87 offen offset:0 lds
    s_add_u32 s87, s87, 7168
    s_add_u32 m0, m0, 1024
    s_nop 0
    buffer_load_dwordx4 v4, s[44:47], s87 offen offset:0 lds
    s_waitcnt lgkmcnt(4)
    s_mul_i32 s87, s78, 56
    s_add_u32 m0, s7, 4096
    s_add_u32 s87, s87, s27
    buffer_load_dwordx4 v4, s[44:47], s87 offen offset:0 lds
    s_add_u32 s87, s87, 7168
    s_add_u32 m0, m0, 1024
    s_nop 0
    buffer_load_dwordx4 v4, s[44:47], s87 offen offset:0 lds
    s_lshl_b32 s64, s6, 1
    s_add_u32 s64, s64, s52
    s_lshl_b32 s68, s64, 8
    s_add_u32 s68, s68, 0xc10000
    s_lshl_b32 s69, s64, 14
    s_add_u32 s69, s69, 0x100000
    s_bfe_u32 s64, s4, 0x20007
    s_lshl_b32 s64, s64, 12
    s_add_u32 s69, s69, s64
    v_lshlrev_b32 v250, 3, v8
    v_lshlrev_b32 v2, 4, v7
    v_bfe_u32 v3, v1, 4, 1
    v_lshl_add_u32 v2, v3, 2, v2
    v_add_u32 v2, v2, v254
    v_bfe_u32 v3, v2, 1, 2
    v_lshlrev_b32 v2, 7, v2
    v_lshl_add_u32 v2, v3, 5, v2
    v_lshl_add_u32 v2, v255, 3, v2
    v_add_u32 v10, 0, v2
    v_xor_b32 v11, 32, v10
    v_xor_b32 v12, 64, v10
    v_xor_b32 v13, 96, v10
    v_lshlrev_b32 v2, 4, v7
    v_bfe_u32 v3, v1, 4, 1
    v_lshl_add_u32 v2, v3, 2, v2
    v_add_u32 v2, v2, v254
    v_lshlrev_b32 v3, 2, v7
    v_sub_u32 v2, v2, v3
    v_add_u32 v2, 8, v2
    v_bfe_u32 v3, v2, 1, 2
    v_lshlrev_b32 v2, 7, v2
    v_lshl_add_u32 v2, v3, 5, v2
    v_lshl_add_u32 v2, v255, 3, v2
    v_add_u32 v16, 0, v2
    v_xor_b32 v17, 32, v16
    v_xor_b32 v18, 64, v16
    v_xor_b32 v19, 96, v16
    v_and_b32 v2, 15, v1
    v_lshlrev_b32 v2, 4, v2
    v_lshl_add_u32 v14, v0, 6, v2
    s_waitcnt vmcnt(6)
    v_lshlrev_b32 v224, 16, v240
    v_and_b32 v225, 0xffff0000, v240
    v_lshlrev_b32 v226, 16, v241
    v_and_b32 v227, 0xffff0000, v241
    v_lshlrev_b32 v228, 16, v242
    v_and_b32 v229, 0xffff0000, v242
    v_lshlrev_b32 v230, 16, v243
    v_and_b32 v231, 0xffff0000, v243
    v_lshlrev_b32 v232, 16, v244
    v_and_b32 v233, 0xffff0000, v244
    v_lshlrev_b32 v234, 16, v245
    v_and_b32 v235, 0xffff0000, v245
    v_lshlrev_b32 v236, 16, v246
    v_and_b32 v237, 0xffff0000, v246
    v_lshlrev_b32 v238, 16, v247
    v_and_b32 v239, 0xffff0000, v247
    ds_read_b64_tr_b16 v[96:97], v10 offset:0
    ds_read_b64_tr_b16 v[98:99], v16 offset:0
    ds_read_b64_tr_b16 v[100:101], v11 offset:0
    ds_read_b64_tr_b16 v[102:103], v17 offset:0
    ds_read_b64_tr_b16 v[104:105], v12 offset:0
    ds_read_b64_tr_b16 v[106:107], v18 offset:0
    ds_read_b64_tr_b16 v[108:109], v13 offset:0
    ds_read_b64_tr_b16 v[110:111], v19 offset:0
    ds_read_b64_tr_b16 v[112:113], v12 offset:3584
    ds_read_b64_tr_b16 v[114:115], v18 offset:3584
    ds_read_b64_tr_b16 v[116:117], v13 offset:3584
    ds_read_b64_tr_b16 v[118:119], v19 offset:3584
    s_waitcnt lgkmcnt(12)
    s_mul_i32 s87, s72, 56
    s_add_u32 m0, s7, 6144
    s_add_u32 s87, s87, s27
    s_add_u32 s87, s87, 28672
    buffer_load_dwordx4 v4, s[44:47], s87 offen offset:0 lds
    s_add_u32 s87, s87, 7168
    s_add_u32 m0, m0, 1024
    s_nop 0
    buffer_load_dwordx4 v4, s[44:47], s87 offen offset:0 lds
    ds_read_b64_tr_b16 v[120:121], v10 offset:3584
    ds_read_b64_tr_b16 v[122:123], v16 offset:3584
    ds_read_b64_tr_b16 v[124:125], v11 offset:3584
    ds_read_b64_tr_b16 v[126:127], v17 offset:3584
    ds_read_b64_tr_b16 v[128:129], v10 offset:7168
    ds_read_b64_tr_b16 v[130:131], v16 offset:7168
    ds_read_b64_tr_b16 v[132:133], v11 offset:7168
    ds_read_b64_tr_b16 v[134:135], v17 offset:7168
    ds_read_b64_tr_b16 v[136:137], v12 offset:7168
    ds_read_b64_tr_b16 v[138:139], v18 offset:7168
    ds_read_b64_tr_b16 v[140:141], v13 offset:7168
    ds_read_b64_tr_b16 v[142:143], v19 offset:7168
    s_mul_i32 s87, s72, 112
    s_lshl_b32 m0, s52, 11
    s_add_u32 s87, s87, s8
    s_add_u32 m0, m0, 57344
    s_nop 0
    buffer_load_dwordx4 v20, s[32:35], s87 offen offset:0 lds
    s_add_u32 s87, s87, 28672
    s_add_u32 m0, m0, 1024
    s_nop 0
    buffer_load_dwordx4 v20, s[32:35], s87 offen offset:0 lds
    ds_read_b64_tr_b16 v[144:145], v12 offset:10752
    ds_read_b64_tr_b16 v[146:147], v18 offset:10752
    ds_read_b64_tr_b16 v[148:149], v13 offset:10752
    ds_read_b64_tr_b16 v[150:151], v19 offset:10752
    ds_read_b64_tr_b16 v[152:153], v10 offset:10752
    ds_read_b64_tr_b16 v[154:155], v16 offset:10752
    ds_read_b64_tr_b16 v[156:157], v11 offset:10752
    ds_read_b64_tr_b16 v[158:159], v17 offset:10752
    ds_read_b64_tr_b16 v[160:161], v10 offset:14336
    ds_read_b64_tr_b16 v[162:163], v16 offset:14336
    ds_read_b64_tr_b16 v[164:165], v11 offset:14336
    ds_read_b64_tr_b16 v[166:167], v17 offset:14336
    s_mul_i32 s87, s73, 112
    s_lshl_b32 m0, s52, 11
    s_add_u32 s87, s87, s8
    s_add_u32 m0, m0, 65536
    s_nop 0
    buffer_load_dwordx4 v20, s[32:35], s87 offen offset:0 lds
    s_add_u32 s87, s87, 28672
    s_add_u32 m0, m0, 1024
    s_nop 0
    buffer_load_dwordx4 v20, s[32:35], s87 offen offset:0 lds
    ds_read_b64_tr_b16 v[168:169], v12 offset:14336
    ds_read_b64_tr_b16 v[170:171], v18 offset:14336
    ds_read_b64_tr_b16 v[172:173], v13 offset:14336
    ds_read_b64_tr_b16 v[174:175], v19 offset:14336
    ds_read_b64_tr_b16 v[176:177], v12 offset:17920
    ds_read_b64_tr_b16 v[178:179], v18 offset:17920
    ds_read_b64_tr_b16 v[180:181], v13 offset:17920
    ds_read_b64_tr_b16 v[182:183], v19 offset:17920
    ds_read_b64_tr_b16 v[184:185], v10 offset:17920
    ds_read_b64_tr_b16 v[186:187], v16 offset:17920
    ds_read_b64_tr_b16 v[188:189], v11 offset:17920
    ds_read_b64_tr_b16 v[190:191], v17 offset:17920
    s_mul_i32 s87, s74, 112
    s_lshl_b32 m0, s52, 11
    s_add_u32 s87, s87, s8
    s_add_u32 m0, m0, 73728
    s_nop 0
    buffer_load_dwordx4 v20, s[32:35], s87 offen offset:0 lds
    s_add_u32 s87, s87, 28672
    s_add_u32 m0, m0, 1024
    s_nop 0
    buffer_load_dwordx4 v20, s[32:35], s87 offen offset:0 lds
    ds_read_b64_tr_b16 v[192:193], v10 offset:21504
    ds_read_b64_tr_b16 v[194:195], v16 offset:21504
    ds_read_b64_tr_b16 v[196:197], v11 offset:21504
    ds_read_b64_tr_b16 v[198:199], v17 offset:21504
    ds_read_b64_tr_b16 v[200:201], v12 offset:21504
    ds_read_b64_tr_b16 v[202:203], v18 offset:21504
    ds_read_b64_tr_b16 v[204:205], v13 offset:21504
    ds_read_b64_tr_b16 v[206:207], v19 offset:21504
    ds_read_b64_tr_b16 v[208:209], v12 offset:25088
    ds_read_b64_tr_b16 v[210:211], v18 offset:25088
    ds_read_b64_tr_b16 v[212:213], v13 offset:25088
    ds_read_b64_tr_b16 v[214:215], v19 offset:25088
    s_mul_i32 s87, s75, 112
    s_lshl_b32 m0, s52, 11
    s_add_u32 s87, s87, s8
    s_add_u32 m0, m0, 81920
    s_nop 0
    buffer_load_dwordx4 v20, s[32:35], s87 offen offset:0 lds
    s_add_u32 s87, s87, 28672
    s_add_u32 m0, m0, 1024
    s_nop 0
    buffer_load_dwordx4 v20, s[32:35], s87 offen offset:0 lds
    ds_read_b64_tr_b16 v[216:217], v10 offset:25088
    ds_read_b64_tr_b16 v[218:219], v16 offset:25088
    ds_read_b64_tr_b16 v[220:221], v11 offset:25088
    ds_read_b64_tr_b16 v[222:223], v17 offset:25088
    ds_read_b64_tr_b16 v[24:25], v10 offset:28672
    ds_read_b64_tr_b16 v[26:27], v16 offset:28672
    ds_read_b64_tr_b16 v[28:29], v11 offset:28672
    ds_read_b64_tr_b16 v[30:31], v17 offset:28672
    ds_read_b64_tr_b16 a[224:225], v12 offset:28672
    ds_read_b64_tr_b16 a[226:227], v18 offset:28672
    ds_read_b64_tr_b16 a[228:229], v13 offset:28672
    ds_read_b64_tr_b16 a[230:231], v19 offset:28672
    s_mul_i32 s87, s76, 112
    s_lshl_b32 m0, s52, 11
    s_add_u32 s87, s87, s8
    s_add_u32 m0, m0, 90112
    s_nop 0
    buffer_load_dwordx4 v20, s[32:35], s87 offen offset:0 lds
    s_add_u32 s87, s87, 28672
    s_add_u32 m0, m0, 1024
    s_nop 0
    buffer_load_dwordx4 v20, s[32:35], s87 offen offset:0 lds
    ds_read_b64_tr_b16 a[232:233], v12 offset:32256
    ds_read_b64_tr_b16 a[234:235], v18 offset:32256
    ds_read_b64_tr_b16 a[236:237], v13 offset:32256
    ds_read_b64_tr_b16 a[238:239], v19 offset:32256
    ds_read_b64_tr_b16 a[240:241], v10 offset:32256
    ds_read_b64_tr_b16 a[242:243], v16 offset:32256
    ds_read_b64_tr_b16 a[244:245], v11 offset:32256
    ds_read_b64_tr_b16 a[246:247], v17 offset:32256
    ds_read_b64_tr_b16 a[248:249], v10 offset:35840
    ds_read_b64_tr_b16 a[250:251], v16 offset:35840
    ds_read_b64_tr_b16 a[252:253], v11 offset:35840
    ds_read_b64_tr_b16 a[254:255], v17 offset:35840
    s_mul_i32 s87, s77, 112
    s_lshl_b32 m0, s52, 11
    s_add_u32 s87, s87, s8
    s_add_u32 m0, m0, 98304
    s_nop 0
    buffer_load_dwordx4 v20, s[32:35], s87 offen offset:0 lds
    s_add_u32 s87, s87, 28672
    s_add_u32 m0, m0, 1024
    s_nop 0
    buffer_load_dwordx4 v20, s[32:35], s87 offen offset:0 lds
    s_mul_i32 s87, s78, 112
    s_lshl_b32 m0, s52, 11
    s_add_u32 s87, s87, s8
    s_add_u32 m0, m0, 106496
    s_nop 0
    buffer_load_dwordx4 v20, s[32:35], s87 offen offset:0 lds
    s_add_u32 s87, s87, 28672
    s_add_u32 m0, m0, 1024
    s_nop 0
    buffer_load_dwordx4 v20, s[32:35], s87 offen offset:0 lds
    s_waitcnt vmcnt(20)
    ds_read_b64_tr_b16 a[32:33], v5 offset:0
    ds_read_b64_tr_b16 a[34:35], v5 offset:1024
    ds_read_b64_tr_b16 a[36:37], v6 offset:0
    ds_read_b64_tr_b16 a[38:39], v6 offset:1024
    s_waitcnt vmcnt(18)
    ds_read_b64_tr_b16 a[40:41], v5 offset:2048
    ds_read_b64_tr_b16 a[42:43], v5 offset:3072
    ds_read_b64_tr_b16 a[44:45], v6 offset:2048
    ds_read_b64_tr_b16 a[46:47], v6 offset:3072
    s_waitcnt vmcnt(16)
    ds_read_b64_tr_b16 a[48:49], v5 offset:4096
    ds_read_b64_tr_b16 a[50:51], v5 offset:5120
    ds_read_b64_tr_b16 a[52:53], v6 offset:4096
    ds_read_b64_tr_b16 a[54:55], v6 offset:5120
    s_waitcnt vmcnt(14)
    ds_read_b64_tr_b16 a[56:57], v5 offset:6144
    ds_read_b64_tr_b16 a[58:59], v5 offset:7168
    ds_read_b64_tr_b16 a[60:61], v6 offset:6144
    ds_read_b64_tr_b16 a[62:63], v6 offset:7168
    s_waitcnt lgkmcnt(12)
    s_mul_i32 s87, s73, 56
    s_add_u32 m0, s7, 0
    s_add_u32 s87, s87, s27
    s_add_u32 s87, s87, 28672
    buffer_load_dwordx4 v4, s[44:47], s87 offen offset:0 lds
    s_add_u32 s87, s87, 7168
    s_add_u32 m0, m0, 1024
    s_nop 0
    buffer_load_dwordx4 v4, s[44:47], s87 offen offset:0 lds
    s_waitcnt lgkmcnt(8)
    s_mul_i32 s87, s74, 56
    s_add_u32 m0, s7, 2048
    s_add_u32 s87, s87, s27
    s_add_u32 s87, s87, 28672
    buffer_load_dwordx4 v4, s[44:47], s87 offen offset:0 lds
    s_add_u32 s87, s87, 7168
    s_add_u32 m0, m0, 1024
    s_nop 0
    buffer_load_dwordx4 v4, s[44:47], s87 offen offset:0 lds
    s_waitcnt lgkmcnt(4)
    s_mul_i32 s87, s75, 56
    s_add_u32 m0, s7, 4096
    s_add_u32 s87, s87, s27
    s_add_u32 s87, s87, 28672
    buffer_load_dwordx4 v4, s[44:47], s87 offen offset:0 lds
    s_add_u32 s87, s87, 7168
    s_add_u32 m0, m0, 1024
    s_nop 0
    buffer_load_dwordx4 v4, s[44:47], s87 offen offset:0 lds
    s_waitcnt lgkmcnt(0)
    s_mul_i32 s87, s76, 56
    s_add_u32 m0, s7, 6144
    s_add_u32 s87, s87, s27
    s_add_u32 s87, s87, 28672
    buffer_load_dwordx4 v4, s[44:47], s87 offen offset:0 lds
    s_add_u32 s87, s87, 7168
    s_add_u32 m0, m0, 1024
    s_nop 0
    buffer_load_dwordx4 v4, s[44:47], s87 offen offset:0 lds
    buffer_load_dwordx2 v[248:249], v250, s[40:43], s68 offen sc1
    s_xor_b32 s59, s69, 0
    buffer_load_dwordx4 v[32:35], v9, s[40:43], s59 offen offset:0 sc1
    buffer_load_dwordx4 v[36:39], v9, s[40:43], s59 offen offset:1024 sc1
    buffer_load_dwordx4 v[40:43], v9, s[40:43], s59 offen offset:2048 sc1
    buffer_load_dwordx4 v[44:47], v9, s[40:43], s59 offen offset:3072 sc1
    s_xor_b32 s59, s69, 4096
    buffer_load_dwordx4 v[48:51], v9, s[40:43], s59 offen offset:0 sc1
    buffer_load_dwordx4 v[52:55], v9, s[40:43], s59 offen offset:1024 sc1
    buffer_load_dwordx4 v[56:59], v9, s[40:43], s59 offen offset:2048 sc1
    buffer_load_dwordx4 v[60:63], v9, s[40:43], s59 offen offset:3072 sc1
    s_xor_b32 s59, s69, 8192
    buffer_load_dwordx4 v[64:67], v9, s[40:43], s59 offen offset:0 sc1
    buffer_load_dwordx4 v[68:71], v9, s[40:43], s59 offen offset:1024 sc1
    buffer_load_dwordx4 v[72:75], v9, s[40:43], s59 offen offset:2048 sc1
    buffer_load_dwordx4 v[76:79], v9, s[40:43], s59 offen offset:3072 sc1
    s_xor_b32 s59, s69, 12288
    buffer_load_dwordx4 v[80:83], v9, s[40:43], s59 offen offset:0 sc1
    buffer_load_dwordx4 v[84:87], v9, s[40:43], s59 offen offset:1024 sc1
    buffer_load_dwordx4 v[88:91], v9, s[40:43], s59 offen offset:2048 sc1
    buffer_load_dwordx4 v[92:95], v9, s[40:43], s59 offen offset:3072 sc1
    s_waitcnt vmcnt(16)
    v_cmp_ne_u32 vcc, s26, v248
    s_nop 4
    s_cbranch_vccz L_pdone_7
    s_mov_b32 s67, 20000
L_poll_5:
    buffer_load_dwordx2 v[248:249], v250, s[40:43], s68 offen sc1
    s_waitcnt vmcnt(0)
    v_cmp_ne_u32 vcc, s26, v248
    s_nop 4
    s_cbranch_vccz L_pgot_6
    s_sub_u32 s67, s67, 1
    s_cbranch_scc0 L_poll_5
L_pgot_6:
    s_xor_b32 s59, s69, 0
    buffer_load_dwordx4 v[32:35], v9, s[40:43], s59 offen offset:0 sc1
    buffer_load_dwordx4 v[36:39], v9, s[40:43], s59 offen offset:1024 sc1
    buffer_load_dwordx4 v[40:43], v9, s[40:43], s59 offen offset:2048 sc1
    buffer_load_dwordx4 v[44:47], v9, s[40:43], s59 offen offset:3072 sc1
    s_xor_b32 s59, s69, 4096
    buffer_load_dwordx4 v[48:51], v9, s[40:43], s59 offen offset:0 sc1
    buffer_load_dwordx4 v[52:55], v9, s[40:43], s59 offen offset:1024 sc1
    buffer_load_dwordx4 v[56:59], v9, s[40:43], s59 offen offset:2048 sc1
    buffer_load_dwordx4 v[60:63], v9, s[40:43], s59 offen offset:3072 sc1
    s_xor_b32 s59, s69, 8192
    buffer_load_dwordx4 v[64:67], v9, s[40:43], s59 offen offset:0 sc1
    buffer_load_dwordx4 v[68:71], v9, s[40:43], s59 offen offset:1024 sc1
    buffer_load_dwordx4 v[72:75], v9, s[40:43], s59 offen offset:2048 sc1
    buffer_load_dwordx4 v[76:79], v9, s[40:43], s59 offen offset:3072 sc1
    s_xor_b32 s59, s69, 12288
    buffer_load_dwordx4 v[80:83], v9, s[40:43], s59 offen offset:0 sc1
    buffer_load_dwordx4 v[84:87], v9, s[40:43], s59 offen offset:1024 sc1
    buffer_load_dwordx4 v[88:91], v9, s[40:43], s59 offen offset:2048 sc1
    buffer_load_dwordx4 v[92:95], v9, s[40:43], s59 offen offset:3072 sc1
L_pdone_7:
    s_waitcnt vmcnt(15) lgkmcnt(15)
    v_mfma_f32_16x16x32_bf16 v[224:227], v[96:99], v[32:35], v[224:227]
    v_add_u32 v15, v32, v33
    v_add3_u32 v15, v34, v35, v15
    v_mfma_f32_16x16x32_bf16 v[228:231], v[100:103], v[32:35], v[228:231]
    v_mfma_f32_16x16x32_bf16 v[232:235], v[104:107], v[32:35], v[232:235]
    v_mfma_f32_16x16x32_bf16 v[236:239], v[108:111], v[32:35], v[236:239]
    ds_read_b64_tr_b16 v[96:97], v12 offset:35840
    ds_read_b64_tr_b16 v[98:99], v18 offset:35840
    ds_read_b64_tr_b16 v[100:101], v13 offset:35840
    ds_read_b64_tr_b16 v[102:103], v19 offset:35840
    ds_read_b64_tr_b16 v[104:105], v12 offset:39424
    ds_read_b64_tr_b16 v[106:107], v18 offset:39424
    ds_read_b64_tr_b16 v[108:109], v13 offset:39424
    ds_read_b64_tr_b16 v[110:111], v19 offset:39424
    s_waitcnt vmcnt(23)
    ds_read_b64_tr_b16 a[64:65], v5 offset:0
    ds_read_b64_tr_b16 a[66:67], v5 offset:1024
    ds_read_b64_tr_b16 a[68:69], v6 offset:0
    ds_read_b64_tr_b16 a[70:71], v6 offset:1024
    s_waitcnt vmcnt(14) lgkmcnt(15)
    v_mfma_f32_16x16x32_bf16 v[224:227], v[112:115], v[36:39], v[224:227]
    v_add3_u32 v15, v36, v37, v15
    v_add3_u32 v15, v38, v39, v15
    v_mfma_f32_16x16x32_bf16 v[228:231], v[116:119], v[36:39], v[228:231]
    v_mfma_f32_16x16x32_bf16 v[232:235], v[120:123], v[36:39], v[232:235]
    v_mfma_f32_16x16x32_bf16 v[236:239], v[124:127], v[36:39], v[236:239]
    ds_read_b64_tr_b16 v[112:113], v10 offset:39424
    ds_read_b64_tr_b16 v[114:115], v16 offset:39424
    ds_read_b64_tr_b16 v[116:117], v11 offset:39424
    ds_read_b64_tr_b16 v[118:119], v17 offset:39424
    ds_read_b64_tr_b16 v[120:121], v10 offset:43008
    ds_read_b64_tr_b16 v[122:123], v16 offset:43008
    ds_read_b64_tr_b16 v[124:125], v11 offset:43008
    ds_read_b64_tr_b16 v[126:127], v17 offset:43008
    s_waitcnt vmcnt(13) lgkmcnt(15)
    v_mfma_f32_16x16x32_bf16 v[224:227], v[128:131], v[40:43], v[224:227]
    v_add3_u32 v15, v40, v41, v15
    v_add3_u32 v15, v42, v43, v15
    v_mfma_f32_16x16x32_bf16 v[228:231], v[132:135], v[40:43], v[228:231]
    v_mfma_f32_16x16x32_bf16 v[232:235], v[136:139], v[40:43], v[232:235]
    v_mfma_f32_16x16x32_bf16 v[236:239], v[140:143], v[40:43], v[236:239]
    ds_read_b64_tr_b16 v[128:129], v12 offset:43008
    ds_read_b64_tr_b16 v[130:131], v18 offset:43008
    ds_read_b64_tr_b16 v[132:133], v13 offset:43008
    ds_read_b64_tr_b16 v[134:135], v19 offset:43008
    ds_read_b64_tr_b16 v[136:137], v12 offset:46592
    ds_read_b64_tr_b16 v[138:139], v18 offset:46592
    ds_read_b64_tr_b16 v[140:141], v13 offset:46592
    ds_read_b64_tr_b16 v[142:143], v19 offset:46592
    s_waitcnt vmcnt(21)
    ds_read_b64_tr_b16 a[72:73], v5 offset:2048
    ds_read_b64_tr_b16 a[74:75], v5 offset:3072
    ds_read_b64_tr_b16 a[76:77], v6 offset:2048
    ds_read_b64_tr_b16 a[78:79], v6 offset:3072
    s_waitcnt vmcnt(12) lgkmcnt(15)
    v_mfma_f32_16x16x32_bf16 v[224:227], v[144:147], v[44:47], v[224:227]
    v_add3_u32 v15, v44, v45, v15
    v_add3_u32 v15, v46, v47, v15
    v_mfma_f32_16x16x32_bf16 v[228:231], v[148:151], v[44:47], v[228:231]
    v_mfma_f32_16x16x32_bf16 v[232:235], v[152:155], v[44:47], v[232:235]
    v_mfma_f32_16x16x32_bf16 v[236:239], v[156:159], v[44:47], v[236:239]
    ds_read_b64_tr_b16 v[144:145], v10 offset:46592
    ds_read_b64_tr_b16 v[146:147], v16 offset:46592
    ds_read_b64_tr_b16 v[148:149], v11 offset:46592
    ds_read_b64_tr_b16 v[150:151], v17 offset:46592
    ds_read_b64_tr_b16 v[152:153], v10 offset:50176
    ds_read_b64_tr_b16 v[154:155], v16 offset:50176
    ds_read_b64_tr_b16 v[156:157], v11 offset:50176
    ds_read_b64_tr_b16 v[158:159], v17 offset:50176
    s_waitcnt vmcnt(11) lgkmcnt(15)
    v_mfma_f32_16x16x32_bf16 v[224:227], v[160:163], v[48:51], v[224:227]
    v_add3_u32 v15, v48, v49, v15
    v_add3_u32 v15, v50, v51, v15
    v_mfma_f32_16x16x32_bf16 v[228:231], v[164:167], v[48:51], v[228:231]
    v_mfma_f32_16x16x32_bf16 v[232:235], v[168:171], v[48:51], v[232:235]
    v_mfma_f32_16x16x32_bf16 v[236:239], v[172:175], v[48:51], v[236:239]
    ds_read_b64_tr_b16 v[160:161], v12 offset:50176
    ds_read_b64_tr_b16 v[162:163], v18 offset:50176
    ds_read_b64_tr_b16 v[164:165], v13 offset:50176
    ds_read_b64_tr_b16 v[166:167], v19 offset:50176
    ds_read_b64_tr_b16 v[168:169], v12 offset:53760
    ds_read_b64_tr_b16 v[170:171], v18 offset:53760
    ds_read_b64_tr_b16 v[172:173], v13 offset:53760
    ds_read_b64_tr_b16 v[174:175], v19 offset:53760
    s_waitcnt vmcnt(19)
    ds_read_b64_tr_b16 a[80:81], v5 offset:4096
    ds_read_b64_tr_b16 a[82:83], v5 offset:5120
    ds_read_b64_tr_b16 a[84:85], v6 offset:4096
    ds_read_b64_tr_b16 a[86:87], v6 offset:5120
    s_waitcnt vmcnt(10) lgkmcnt(15)
    v_mfma_f32_16x16x32_bf16 v[224:227], v[176:179], v[52:55], v[224:227]
    v_add3_u32 v15, v52, v53, v15
    v_add3_u32 v15, v54, v55, v15
    v_mfma_f32_16x16x32_bf16 v[228:231], v[180:183], v[52:55], v[228:231]
    v_mfma_f32_16x16x32_bf16 v[232:235], v[184:187], v[52:55], v[232:235]
    v_mfma_f32_16x16x32_bf16 v[236:239], v[188:191], v[52:55], v[236:239]
    ds_read_b64_tr_b16 v[176:177], v10 offset:53760
    ds_read_b64_tr_b16 v[178:179], v16 offset:53760
    ds_read_b64_tr_b16 v[180:181], v11 offset:53760
    ds_read_b64_tr_b16 v[182:183], v17 offset:53760
    s_waitcnt vmcnt(9) lgkmcnt(15)
    v_mfma_f32_16x16x32_bf16 v[224:227], v[192:195], v[56:59], v[224:227]
    v_add3_u32 v15, v56, v57, v15
    v_add3_u32 v15, v58, v59, v15
    v_mfma_f32_16x16x32_bf16 v[228:231], v[196:199], v[56:59], v[228:231]
    v_mfma_f32_16x16x32_bf16 v[232:235], v[200:203], v[56:59], v[232:235]
    v_mfma_f32_16x16x32_bf16 v[236:239], v[204:207], v[56:59], v[236:239]
    s_waitcnt vmcnt(17)
    ds_read_b64_tr_b16 a[88:89], v5 offset:6144
    ds_read_b64_tr_b16 a[90:91], v5 offset:7168
    ds_read_b64_tr_b16 a[92:93], v6 offset:6144
    ds_read_b64_tr_b16 a[94:95], v6 offset:7168
    s_waitcnt vmcnt(8) lgkmcnt(15)
    v_mfma_f32_16x16x32_bf16 v[224:227], v[208:211], v[60:63], v[224:227]
    v_add3_u32 v15, v60, v61, v15
    v_add3_u32 v15, v62, v63, v15
    v_mfma_f32_16x16x32_bf16 v[228:231], v[212:215], v[60:63], v[228:231]
    v_mfma_f32_16x16x32_bf16 v[232:235], v[216:219], v[60:63], v[232:235]
    v_mfma_f32_16x16x32_bf16 v[236:239], v[220:223], v[60:63], v[236:239]
    s_waitcnt vmcnt(7) lgkmcnt(15)
    v_mfma_f32_16x16x32_bf16 v[224:227], v[24:27], v[64:67], v[224:227]
    v_add3_u32 v15, v64, v65, v15
    v_add3_u32 v15, v66, v67, v15
    v_mfma_f32_16x16x32_bf16 v[228:231], v[28:31], v[64:67], v[228:231]
    v_mfma_f32_16x16x32_bf16 v[232:235], a[224:227], v[64:67], v[232:235]
    v_mfma_f32_16x16x32_bf16 v[236:239], a[228:231], v[64:67], v[236:239]
    s_waitcnt lgkmcnt(15)
    s_mul_i32 s87, s77, 56
    s_add_u32 m0, s7, 0
    s_add_u32 s87, s87, s27
    s_add_u32 s87, s87, 28672
    buffer_load_dwordx4 v4, s[44:47], s87 offen offset:0 lds
    s_add_u32 s87, s87, 7168
    s_add_u32 m0, m0, 1024
    s_nop 0
    buffer_load_dwordx4 v4, s[44:47], s87 offen offset:0 lds
    s_waitcnt vmcnt(8) lgkmcnt(15)
    v_mfma_f32_16x16x32_bf16 v[224:227], a[232:235], v[68:71], v[224:227]
    v_add3_u32 v15, v68, v69, v15
    v_add3_u32 v15, v70, v71, v15
    v_mfma_f32_16x16x32_bf16 v[228:231], a[236:239], v[68:71], v[228:231]
    v_mfma_f32_16x16x32_bf16 v[232:235], a[240:243], v[68:71], v[232:235]
    v_mfma_f32_16x16x32_bf16 v[236:239], a[244:247], v[68:71], v[236:239]
    s_waitcnt vmcnt(7) lgkmcnt(15)
    v_mfma_f32_16x16x32_bf16 v[224:227], a[248:251], v[72:75], v[224:227]
    v_add3_u32 v15, v72, v73, v15
    v_add3_u32 v15, v74, v75, v15
    v_mfma_f32_16x16x32_bf16 v[228:231], a[252:255], v[72:75], v[228:231]
    v_mfma_f32_16x16x32_bf16 v[232:235], v[96:99], v[72:75], v[232:235]
    v_mfma_f32_16x16x32_bf16 v[236:239], v[100:103], v[72:75], v[236:239]
    s_waitcnt lgkmcnt(15)
    s_mul_i32 s87, s78, 56
    s_add_u32 m0, s7, 2048
    s_add_u32 s87, s87, s27
    s_add_u32 s87, s87, 28672
    buffer_load_dwordx4 v4, s[44:47], s87 offen offset:0 lds
    s_add_u32 s87, s87, 7168
    s_add_u32 m0, m0, 1024
    s_nop 0
    buffer_load_dwordx4 v4, s[44:47], s87 offen offset:0 lds
    s_waitcnt vmcnt(8) lgkmcnt(15)
    v_mfma_f32_16x16x32_bf16 v[224:227], v[104:107], v[76:79], v[224:227]
    v_add3_u32 v15, v76, v77, v15
    v_add3_u32 v15, v78, v79, v15
    v_mfma_f32_16x16x32_bf16 v[228:231], v[108:111], v[76:79], v[228:231]
    v_mfma_f32_16x16x32_bf16 v[232:235], v[112:115], v[76:79], v[232:235]
    v_mfma_f32_16x16x32_bf16 v[236:239], v[116:119], v[76:79], v[236:239]
    s_waitcnt vmcnt(7) lgkmcnt(15)
    v_mfma_f32_16x16x32_bf16 v[224:227], v[120:123], v[80:83], v[224:227]
    v_add3_u32 v15, v80, v81, v15
    v_add3_u32 v15, v82, v83, v15
    v_mfma_f32_16x16x32_bf16 v[228:231], v[124:127], v[80:83], v[228:231]
    v_mfma_f32_16x16x32_bf16 v[232:235], v[128:131], v[80:83], v[232:235]
    v_mfma_f32_16x16x32_bf16 v[236:239], v[132:135], v[80:83], v[236:239]
    s_waitcnt lgkmcnt(8)
    s_mul_i32 s87, s72, 56
    s_add_u32 m0, s7, 4096
    s_add_u32 s87, s87, s27
    s_add_u32 s87, s87, 57344
    buffer_load_dwordx4 v4, s[44:47], s87 offen offset:0 lds
    s_add_u32 s87, s87, 7168
    s_add_u32 m0, m0, 1024
    s_nop 0
    buffer_load_dwordx4 v4, s[44:47], s87 offen offset:0 lds
    s_waitcnt vmcnt(8) lgkmcnt(15)
    v_mfma_f32_16x16x32_bf16 v[224:227], v[136:139], v[84:87], v[224:227]
    v_add3_u32 v15, v84, v85, v15
    v_add3_u32 v15, v86, v87, v15
    v_mfma_f32_16x16x32_bf16 v[228:231], v[140:143], v[84:87], v[228:231]
    v_mfma_f32_16x16x32_bf16 v[232:235], v[144:147], v[84:87], v[232:235]
    v_mfma_f32_16x16x32_bf16 v[236:239], v[148:151], v[84:87], v[236:239]
    s_waitcnt vmcnt(7) lgkmcnt(15)
    v_mfma_f32_16x16x32_bf16 v[224:227], v[152:155], v[88:91], v[224:227]
    v_add3_u32 v15, v88, v89, v15
    v_add3_u32 v15, v90, v91, v15
    v_mfma_f32_16x16x32_bf16 v[228:231], v[156:159], v[88:91], v[228:231]
    v_mfma_f32_16x16x32_bf16 v[232:235], v[160:163], v[88:91], v[232:235]
    v_mfma_f32_16x16x32_bf16 v[236:239], v[164:167], v[88:91], v[236:239]
    s_waitcnt lgkmcnt(0)
    s_mul_i32 s87, s73, 56
    s_add_u32 m0, s7, 6144
    s_add_u32 s87, s87, s27
    s_add_u32 s87, s87, 57344
    buffer_load_dwordx4 v4, s[44:47], s87 offen offset:0 lds
    s_add_u32 s87, s87, 7168
    s_add_u32 m0, m0, 1024
    s_nop 0
    buffer_load_dwordx4 v4, s[44:47], s87 offen offset:0 lds
    s_waitcnt vmcnt(8) lgkmcnt(4)
    v_mfma_f32_16x16x32_bf16 v[224:227], v[168:171], v[92:95], v[224:227]
    v_add3_u32 v15, v92, v93, v15
    v_add3_u32 v15, v94, v95, v15
    v_mfma_f32_16x16x32_bf16 v[228:231], v[172:175], v[92:95], v[228:231]
    v_mfma_f32_16x16x32_bf16 v[232:235], v[176:179], v[92:95], v[232:235]
    v_mfma_f32_16x16x32_bf16 v[236:239], v[180:183], v[92:95], v[236:239]
    s_nop 11
L_cont_c:
    v_cmp_gt_u32 vcc, 32, v1
    s_lshr_b32 s57, s52, 1
    s_add_u32 s57, s57, s6
    v_cndmask_b32 v3, 0, v249, vcc
    s_and_b32 s58, s52, 1
    s_mul_i32 s59, s57, 28672
    v_sub_u32 v3, v15, v3
    s_lshl_b32 s60, s4, 5
    s_add_u32 s59, s59, s60
    v_add_u32_dpp v3, v3, v3 row_ror:8 row_mask:0xf bank_mask:0xf
    s_lshl_b32 s60, s58, 8
    s_add_u32 s59, s59, s60
    v_add_u32_dpp v3, v3, v3 row_ror:4 row_mask:0xf bank_mask:0xf
    s_add_u32 s59, s59, 0x300000
    s_lshl_b32 s60, s57, 9
    v_add_u32_dpp v3, v3, v3 row_ror:2 row_mask:0xf bank_mask:0xf
    s_mul_i32 s87, s58, 224
    s_add_u32 s60, s60, s87
    v_add_u32_dpp v3, v3, v3 row_ror:1 row_mask:0xf bank_mask:0xf
    s_lshr_b32 s87, s4, 2
    s_add_u32 s60, s60, s87
    s_add_u32 s60, s60, 0xc20000
    v_readlane_b32 s64, v3, 0
    v_readlane_b32 s65, v3, 16
    v_readlane_b32 s66, v3, 32
    v_readlane_b32 s67, v3, 48
    v_cvt_pk_bf16_f32 v96, v224, v225
    v_cvt_pk_bf16_f32 v97, v226, v227
    v_cvt_pk_bf16_f32 v98, v228, v229
    v_cvt_pk_bf16_f32 v99, v230, v231
    v_cvt_pk_bf16_f32 v100, v232, v233
    v_cvt_pk_bf16_f32 v101, v234, v235
    v_cvt_pk_bf16_f32 v102, v236, v237
    v_cvt_pk_bf16_f32 v103, v238, v239
    s_add_u32 s64, s64, s65
    s_add_u32 s66, s66, s67
    s_add_u32 s64, s64, s66
    s_cmp_eq_u32 s64, 0
    s_nop 0
    s_cbranch_scc1 L_vok_8
    s_sub_u32 s3, s3, 1
    s_cbranch_scc0 L_slow_c
L_vok_8:
    buffer_store_dwordx4 v[96:99], v14, s[40:43], s59 offen offset:0 sc1
    buffer_store_dwordx4 v[100:103], v14, s[40:43], s59 offen offset:2048 sc1
    v_add_u32 v253, v96, v97
    v_add3_u32 v253, v98, v99, v253
    v_add3_u32 v253, v100, v101, v253
    v_add3_u32 v253, v102, v103, v253
    v_lshlrev_b32 v40, 16, v96
    v_and_b32 v41, 0xffff0000, v96
    v_add_u32_dpp v253, v253, v253 row_ror:8 row_mask:0xf bank_mask:0xf
    v_lshlrev_b32 v42, 16, v97
    v_and_b32 v43, 0xffff0000, v97
    v_add_u32_dpp v253, v253, v253 row_ror:4 row_mask:0xf bank_mask:0xf
    v_lshlrev_b32 v44, 16, v98
    v_and_b32 v45, 0xffff0000, v98
    v_add_u32_dpp v253, v253, v253 row_ror:2 row_mask:0xf bank_mask:0xf
    v_lshlrev_b32 v46, 16, v99
    v_and_b32 v47, 0xffff0000, v99
    v_add_u32_dpp v253, v253, v253 row_ror:1 row_mask:0xf bank_mask:0xf
    buffer_store_dwordx2 v[252:253], v0, s[40:43], s60 offen offset:0 sc1
    v_lshlrev_b32 v48, 16, v100
    v_and_b32 v49, 0xffff0000, v100
    v_lshlrev_b32 v50, 16, v101
    v_and_b32 v51, 0xffff0000, v101
    v_lshlrev_b32 v52, 16, v102
    v_and_b32 v53, 0xffff0000, v102
    v_lshlrev_b32 v54, 16, v103
    v_and_b32 v55, 0xffff0000, v103
    v_pk_add_f32 v[56:57], v[40:41], v[42:43]
    v_pk_mul_f32 v[58:59], v[40:41], v[40:41]
    v_pk_fma_f32 v[58:59], v[42:43], v[42:43], v[58:59]
    v_pk_add_f32 v[56:57], v[56:57], v[44:45]
    v_pk_fma_f32 v[58:59], v[44:45], v[44:45], v[58:59]
    v_pk_add_f32 v[56:57], v[56:57], v[46:47]
    v_pk_fma_f32 v[58:59], v[46:47], v[46:47], v[58:59]
    v_pk_add_f32 v[56:57], v[56:57], v[48:49]
    v_pk_fma_f32 v[58:59], v[48:49], v[48:49], v[58:59]
    v_pk_add_f32 v[56:57], v[56:57], v[50:51]
    v_pk_fma_f32 v[58:59], v[50:51], v[50:51], v[58:59]
    v_pk_add_f32 v[56:57], v[56:57], v[52:53]
    v_pk_fma_f32 v[58:59], v[52:53], v[52:53], v[58:59]
    v_pk_add_f32 v[56:57], v[56:57], v[54:55]
    v_pk_fma_f32 v[58:59], v[54:55], v[54:55], v[58:59]
    v_add_f32 v56, v56, v57
    v_add_f32 v57, v58, v59
    s_lshl_b32 s65, s57, 12
    s_lshl_b32 s66, s4, 2
    v_permlane32_swap_b32 v56, v57
    v_add_f32 v56, v56, v57
    v_mov_b32 v57, v56
    s_add_u32 s65, s65, s66
    s_lshl_b32 s66, s58, 8
    v_permlane16_swap_b32 v56, v57
    v_add_f32 v56, v56, v57
    v_mov_b32 v57, v56
    v_mov_b32 v58, v252
    v_mov_b32 v59, v252
    v_permlane32_swap_b32 v56, v57
    s_add_u32 s65, s65, s66
    s_add_u32 s65, s65, 0xc80000
    v_and_b32 v2, 0xff, v14
    buffer_store_dwordx4 v[56:59], v2, s[40:43], s65 offen sc1
    s_lshr_b32 s65, s52, 1
    s_lshl_b32 s65, s65, 12
    s_add_u32 s65, s65, s66
    s_add_u32 s65, s65, 122880
    v_add_u32 v2, s65, v14
    ds_write_b128 v2, v[96:99]
    ds_write_b128 v2, v[100:103] offset:2048
    s_waitcnt vmcnt(37)
    s_barrier
    s_add_u32 s8, s8, 128
    s_waitcnt vmcnt(10)
    ds_read_b64_tr_b16 a[96:97], v5 offset:0
    ds_read_b64_tr_b16 a[98:99], v5 offset:1024
    ds_read_b64_tr_b16 a[100:101], v6 offset:0
    ds_read_b64_tr_b16 a[102:103], v6 offset:1024
    s_waitcnt vmcnt(8)
    ds_read_b64_tr_b16 a[104:105], v5 offset:2048
    ds_read_b64_tr_b16 a[106:107], v5 offset:3072
    ds_read_b64_tr_b16 a[108:109], v6 offset:2048
    ds_read_b64_tr_b16 a[110:111], v6 offset:3072
    s_waitcnt vmcnt(6)
    ds_read_b64_tr_b16 a[112:113], v5 offset:4096
    ds_read_b64_tr_b16 a[114:115], v5 offset:5120
    ds_read_b64_tr_b16 a[116:117], v6 offset:4096
    ds_read_b64_tr_b16 a[118:119], v6 offset:5120
    s_waitcnt vmcnt(4)
    ds_read_b64_tr_b16 a[120:121], v5 offset:6144
    ds_read_b64_tr_b16 a[122:123], v5 offset:7168
    ds_read_b64_tr_b16 a[124:125], v6 offset:6144
    ds_read_b64_tr_b16 a[126:127], v6 offset:7168
    s_waitcnt lgkmcnt(12)
    s_mul_i32 s87, s74, 56
    s_add_u32 m0, s7, 0
    s_add_u32 s87, s87, s27
    s_add_u32 s87, s87, 57344
    buffer_load_dwordx4 v4, s[44:47], s87 offen offset:0 lds
    s_add_u32 s87, s87, 7168
    s_add_u32 m0, m0, 1024
    s_nop 0
    buffer_load_dwordx4 v4, s[44:47], s87 offen offset:0 lds
    s_waitcnt lgkmcnt(8)
    s_mul_i32 s87, s75, 56
    s_add_u32 m0, s7, 2048
    s_add_u32 s87, s87, s27
    s_add_u32 s87, s87, 57344
    buffer_load_dwordx4 v4, s[44:47], s87 offen offset:0 lds
    s_add_u32 s87, s87, 7168
    s_add_u32 m0, m0, 1024
    s_nop 0
    buffer_load_dwordx4 v4, s[44:47], s87 offen offset:0 lds
    s_waitcnt lgkmcnt(4)
    s_mul_i32 s87, s76, 56
    s_add_u32 m0, s7, 4096
    s_add_u32 s87, s87, s27
    s_add_u32 s87, s87, 57344
    buffer_load_dwordx4 v4, s[44:47], s87 offen offset:0 lds
    s_add_u32 s87, s87, 7168
    s_add_u32 m0, m0, 1024
    s_nop 0
    buffer_load_dwordx4 v4, s[44:47], s87 offen offset:0 lds
    s_waitcnt lgkmcnt(0)
    s_mul_i32 s87, s77, 56
    s_add_u32 m0, s7, 6144
    s_add_u32 s87, s87, s27
    s_add_u32 s87, s87, 57344
    buffer_load_dwordx4 v4, s[44:47], s87 offen offset:0 lds
    s_add_u32 s87, s87, 7168
    s_add_u32 m0, m0, 1024
    s_nop 0
    buffer_load_dwordx4 v4, s[44:47], s87 offen offset:0 lds
    s_mul_i32 s87, s72, 112
    s_lshl_b32 m0, s52, 11
    s_add_u32 s87, s87, s8
    s_add_u32 m0, m0, 0
    s_nop 0
    buffer_load_dwordx4 v20, s[32:35], s87 offen offset:0 lds
    s_add_u32 s87, s87, 28672
    s_add_u32 m0, m0, 1024
    s_nop 0
    buffer_load_dwordx4 v20, s[32:35], s87 offen offset:0 lds
    s_mul_i32 s87, s73, 112
    s_lshl_b32 m0, s52, 11
    s_add_u32 s87, s87, s8
    s_add_u32 m0, m0, 8192
    s_nop 0
    buffer_load_dwordx4 v20, s[32:35], s87 offen offset:0 lds
    s_add_u32 s87, s87, 28672
    s_add_u32 m0, m0, 1024
    s_nop 0
    buffer_load_dwordx4 v20, s[32:35], s87 offen offset:0 lds
    s_mul_i32 s87, s74, 112
    s_lshl_b32 m0, s52, 11
    s_add_u32 s87, s87, s8
    s_add_u32 m0, m0, 16384
    s_nop 0
    buffer_load_dwordx4 v20, s[32:35], s87 offen offset:0 lds
    s_add_u32 s87, s87, 28672
    s_add_u32 m0, m0, 1024
    s_nop 0
    buffer_load_dwordx4 v20, s[32:35], s87 offen offset:0 lds
    s_mul_i32 s87, s75, 112
    s_lshl_b32 m0, s52, 11
    s_add_u32 s87, s87, s8
    s_add_u32 m0, m0, 24576
    s_nop 0
    buffer_load_dwordx4 v20, s[32:35], s87 offen offset:0 lds
    s_add_u32 s87, s87, 28672
    s_add_u32 m0, m0, 1024
    s_nop 0
    buffer_load_dwordx4 v20, s[32:35], s87 offen offset:0 lds
    s_mul_i32 s87, s76, 112
    s_lshl_b32 m0, s52, 11
    s_add_u32 s87, s87, s8
    s_add_u32 m0, m0, 32768
    s_nop 0
    buffer_load_dwordx4 v20, s[32:35], s87 offen offset:0 lds
    s_add_u32 s87, s87, 28672
    s_add_u32 m0, m0, 1024
    s_nop 0
    buffer_load_dwordx4 v20, s[32:35], s87 offen offset:0 lds
    s_mul_i32 s87, s77, 112
    s_lshl_b32 m0, s52, 11
    s_add_u32 s87, s87, s8
    s_add_u32 m0, m0, 40960
    s_nop 0
    buffer_load_dwordx4 v20, s[32:35], s87 offen offset:0 lds
    s_add_u32 s87, s87, 28672
    s_add_u32 m0, m0, 1024
    s_nop 0
    buffer_load_dwordx4 v20, s[32:35], s87 offen offset:0 lds
    s_mul_i32 s87, s78, 112
    s_lshl_b32 m0, s52, 11
    s_add_u32 s87, s87, s8
    s_add_u32 m0, m0, 49152
    s_nop 0
    buffer_load_dwordx4 v20, s[32:35], s87 offen offset:0 lds
    s_add_u32 s87, s87, 28672
    s_add_u32 m0, m0, 1024
    s_nop 0
    buffer_load_dwordx4 v20, s[32:35], s87 offen offset:0 lds
    s_waitcnt vmcnt(20)
    ds_read_b64_tr_b16 a[128:129], v5 offset:0
    ds_read_b64_tr_b16 a[130:131], v5 offset:1024
    ds_read_b64_tr_b16 a[132:133], v6 offset:0
    ds_read_b64_tr_b16 a[134:135], v6 offset:1024
    s_waitcnt vmcnt(18)
    ds_read_b64_tr_b16 a[136:137], v5 offset:2048
    ds_read_b64_tr_b16 a[138:139], v5 offset:3072
    ds_read_b64_tr_b16 a[140:141], v6 offset:2048
    ds_read_b64_tr_b16 a[142:143], v6 offset:3072
    s_waitcnt vmcnt(16)
    ds_read_b64_tr_b16 a[144:145], v5 offset:4096
    ds_read_b64_tr_b16 a[146:147], v5 offset:5120
    ds_read_b64_tr_b16 a[148:149], v6 offset:4096
    ds_read_b64_tr_b16 a[150:151], v6 offset:5120
    s_waitcnt vmcnt(14)
    ds_read_b64_tr_b16 a[152:153], v5 offset:6144
    ds_read_b64_tr_b16 a[154:155], v5 offset:7168
    ds_read_b64_tr_b16 a[156:157], v6 offset:6144
    ds_read_b64_tr_b16 a[158:159], v6 offset:7168
    s_waitcnt lgkmcnt(12)
    s_mul_i32 s87, s78, 56
    s_add_u32 m0, s7, 0
    s_add_u32 s87, s87, s27
    s_add_u32 s87, s87, 57344
    buffer_load_dwordx4 v4, s[44:47], s87 offen offset:0 lds
    s_add_u32 s87, s87, 7168
    s_add_u32 m0, m0, 1024
    s_nop 0
    buffer_load_dwordx4 v4, s[44:47], s87 offen offset:0 lds
    s_waitcnt lgkmcnt(8)
    s_mul_i32 s87, s72, 56
    s_add_u32 m0, s7, 2048
    s_add_u32 s87, s87, s27
    s_add_u32 s87, s87, 86016
    buffer_load_dwordx4 v4, s[44:47], s87 offen offset:0 lds
    s_add_u32 s87, s87, 7168
    s_add_u32 m0, m0, 1024
    s_nop 0
    buffer_load_dwordx4 v4, s[44:47], s87 offen offset:0 lds
    s_waitcnt lgkmcnt(4)
    s_mul_i32 s87, s73, 56
    s_add_u32 m0, s7, 4096
    s_add_u32 s87, s87, s27
    s_add_u32 s87, s87, 86016
    buffer_load_dwordx4 v4, s[44:47], s87 offen offset:0 lds
    s_add_u32 s87, s87, 7168
    s_add_u32 m0, m0, 1024
    s_nop 0
    buffer_load_dwordx4 v4, s[44:47], s87 offen offset:0 lds
    s_waitcnt lgkmcnt(0)
    s_mul_i32 s87, s74, 56
    s_add_u32 m0, s7, 6144
    s_add_u32 s87, s87, s27
    s_add_u32 s87, s87, 86016
    buffer_load_dwordx4 v4, s[44:47], s87 offen offset:0 lds
    s_add_u32 s87, s87, 7168
    s_add_u32 m0, m0, 1024
    s_nop 0
    buffer_load_dwordx4 v4, s[44:47], s87 offen offset:0 lds
    s_lshl_b32 s64, s55, 2
    s_add_u32 s64, s64, s52
    s_lshl_b32 s68, s64, 9
    s_add_u32 s68, s68, 0xc20000
    s_mul_i32 s69, s64, 28672
    s_add_u32 s69, s69, 0x300000
    s_lshl_b32 s57, s64, 12
    s_add_u32 s57, s57, 0xc80000
    s_lshl_b32 s58, s56, 11
    s_add_u32 s58, s58, 0xcc0000
    s_mul_i32 s92, s64, 114688
    s_lshl_b32 s65, s56, 13
    s_add_u32 s92, s92, s65
    s_add_u32 s92, s92, 0x500000
    s_lshl_b32 s93, s55, 14
    s_mul_i32 s65, s52, 448
    s_add_u32 s93, s93, s65
    s_lshl_b32 s65, s56, 5
    s_add_u32 s93, s93, s65
    s_add_u32 s93, s93, 0xc30000
    v_min_u32 v250, 55, v1
    v_lshlrev_b32 v250, 3, v250
    v_lshl_add_u32 v2, v7, 2, v254
    v_lshlrev_b32 v2, 7, v2
    v_lshrrev_b32 v3, 1, v254
    v_lshl_add_u32 v2, v3, 6, v2
    v_bfe_u32 v3, v1, 4, 1
    v_lshl_add_u32 v2, v3, 5, v2
    v_lshl_add_u32 v2, v255, 3, v2
    v_add_u32 v10, 57344, v2
    v_xor_b32 v11, 64, v10
    v_subrev_u32 v12, 57344, v10
    v_subrev_u32 v13, 57344, v11
    v_mov_b32 v247, 0
    v_lshlrev_b32 v15, 4, v8
    buffer_load_dwordx4 v[16:19], v15, s[40:43], s58 offen offset:0 sc1
    buffer_load_dwordx4 v[20:23], v15, s[40:43], s58 offen offset:512 sc1
    buffer_load_dwordx4 v[24:27], v15, s[40:43], s58 offen offset:1024 sc1
    buffer_load_dwordx4 v[28:31], v15, s[40:43], s58 offen offset:1536 sc1
    s_mov_b32 s48, s18
    s_mov_b32 s49, s19
    s_mov_b32 s50, 0x380
    s_mov_b32 s51, 0x20000
    s_and_b32 s64, s52, 1
    s_lshl_b32 s64, s64, 6
    s_add_u32 s64, s64, s4
    v_lshlrev_b32 v2, 1, v8
    v_lshl_add_u32 v2, v7, 30, v2
    buffer_load_ushort a224, v2, s[48:51], s64 offen
    v_accvgpr_write_b32 a225, 0
    v_accvgpr_write_b32 a226, 0
    v_accvgpr_write_b32 a227, 0
    buffer_load_dwordx2 v[248:249], v250, s[40:43], s68 offen sc1
    s_lshl1_add_u32 s59, s72, s69
    buffer_load_dwordx4 v[32:35], v9, s[40:43], s59 offen offset:0 sc1
    buffer_load_dwordx4 v[36:39], v9, s[40:43], s59 offen offset:1024 sc1
    buffer_load_dwordx4 v[40:43], v9, s[40:43], s59 offen offset:2048 sc1
    buffer_load_dwordx4 v[44:47], v9, s[40:43], s59 offen offset:3072 sc1
    s_lshl1_add_u32 s59, s73, s69
    buffer_load_dwordx4 v[48:51], v9, s[40:43], s59 offen offset:0 sc1
    buffer_load_dwordx4 v[52:55], v9, s[40:43], s59 offen offset:1024 sc1
    buffer_load_dwordx4 v[56:59], v9, s[40:43], s59 offen offset:2048 sc1
    buffer_load_dwordx4 v[60:63], v9, s[40:43], s59 offen offset:3072 sc1
    s_lshl1_add_u32 s59, s74, s69
    buffer_load_dwordx4 v[64:67], v9, s[40:43], s59 offen offset:0 sc1
    buffer_load_dwordx4 v[68:71], v9, s[40:43], s59 offen offset:1024 sc1
    buffer_load_dwordx4 v[192:195], v9, s[40:43], s57 offen offset:0 sc1
    buffer_load_dwordx4 v[196:199], v9, s[40:43], s57 offen offset:1024 sc1
    buffer_load_dwordx4 v[200:203], v9, s[40:43], s57 offen offset:2048 sc1
    buffer_load_dwordx4 v[204:207], v15, s[40:43], s57 offen offset:3072 sc1
    buffer_load_dwordx4 v[72:75], v9, s[40:43], s59 offen offset:2048 sc1
    buffer_load_dwordx4 v[76:79], v9, s[40:43], s59 offen offset:3072 sc1
    s_waitcnt vmcnt(16)
    v_cmp_ne_u32 vcc, s26, v248
    s_nop 4
    s_cbranch_vccz L_pdone_11
    s_mov_b32 s67, 20000
L_poll_9:
    buffer_load_dwordx2 v[248:249], v250, s[40:43], s68 offen sc1
    s_waitcnt vmcnt(0)
    v_cmp_ne_u32 vcc, s26, v248
    s_nop 4
    s_cbranch_vccz L_pgot_10
    s_sub_u32 s67, s67, 1
    s_cbranch_scc0 L_poll_9
L_pgot_10:
    s_lshl1_add_u32 s59, s72, s69
    buffer_load_dwordx4 v[32:35], v9, s[40:43], s59 offen offset:0 sc1
    buffer_load_dwordx4 v[36:39], v9, s[40:43], s59 offen offset:1024 sc1
    buffer_load_dwordx4 v[40:43], v9, s[40:43], s59 offen offset:2048 sc1
    buffer_load_dwordx4 v[44:47], v9, s[40:43], s59 offen offset:3072 sc1
    s_lshl1_add_u32 s59, s73, s69
    buffer_load_dwordx4 v[48:51], v9, s[40:43], s59 offen offset:0 sc1
    buffer_load_dwordx4 v[52:55], v9, s[40:43], s59 offen offset:1024 sc1
    buffer_load_dwordx4 v[56:59], v9, s[40:43], s59 offen offset:2048 sc1
    buffer_load_dwordx4 v[60:63], v9, s[40:43], s59 offen offset:3072 sc1
    s_lshl1_add_u32 s59, s74, s69
    buffer_load_dwordx4 v[64:67], v9, s[40:43], s59 offen offset:0 sc1
    buffer_load_dwordx4 v[68:71], v9, s[40:43], s59 offen offset:1024 sc1
    buffer_load_dwordx4 v[192:195], v9, s[40:43], s57 offen offset:0 sc1
    buffer_load_dwordx4 v[196:199], v9, s[40:43], s57 offen offset:1024 sc1
    buffer_load_dwordx4 v[200:203], v9, s[40:43], s57 offen offset:2048 sc1
    buffer_load_dwordx4 v[204:207], v15, s[40:43], s57 offen offset:3072 sc1
    buffer_load_dwordx4 v[72:75], v9, s[40:43], s59 offen offset:2048 sc1
    buffer_load_dwordx4 v[76:79], v9, s[40:43], s59 offen offset:3072 sc1
L_pdone_11:
    ds_read_b64_tr_b16 v[208:209], v10 offset:0
    ds_read_b64_tr_b16 v[210:211], v10 offset:2048
    ds_read_b64_tr_b16 v[212:213], v11 offset:0
    ds_read_b64_tr_b16 v[214:215], v11 offset:2048
    ds_read_b64_tr_b16 v[216:217], v10 offset:1024
    ds_read_b64_tr_b16 v[218:219], v10 offset:3072
    ds_read_b64_tr_b16 v[220:221], v11 offset:1024
    ds_read_b64_tr_b16 v[222:223], v11 offset:3072
    ds_read_b64_tr_b16 v[224:225], v10 offset:4096
    ds_read_b64_tr_b16 v[226:227], v10 offset:6144
    ds_read_b64_tr_b16 v[228:229], v11 offset:4096
    ds_read_b64_tr_b16 v[230:231], v11 offset:6144
    s_waitcnt vmcnt(15) lgkmcnt(8)
    v_mfma_f32_32x32x16_bf16 v[144:159], v[208:211], v[32:35], 0
    ds_read_b64_tr_b16 v[232:233], v10 offset:5120
    ds_read_b64_tr_b16 v[234:235], v10 offset:7168
    v_add_u32 v14, v32, v33
    v_add3_u32 v14, v34, v35, v14
    v_mfma_f32_32x32x16_bf16 v[160:175], v[212:215], v[32:35], 0
    ds_read_b64_tr_b16 v[236:237], v11 offset:5120
    ds_read_b64_tr_b16 v[238:239], v11 offset:7168
    s_lshl1_add_u32 s59, s75, s69
    buffer_load_dwordx4 v[80:83], v9, s[40:43], s59 offen offset:0 sc1
    s_waitcnt vmcnt(15) lgkmcnt(8)
    v_mfma_f32_32x32x16_bf16 v[144:159], v[216:219], v[36:39], v[144:159]
    ds_read_b64_tr_b16 v[208:209], v10 offset:8192
    ds_read_b64_tr_b16 v[210:211], v10 offset:10240
    v_add3_u32 v14, v36, v37, v14
    v_add3_u32 v14, v38, v39, v14
    v_mfma_f32_32x32x16_bf16 v[160:175], v[220:223], v[36:39], v[160:175]
    ds_read_b64_tr_b16 v[212:213], v11 offset:8192
    ds_read_b64_tr_b16 v[214:215], v11 offset:10240
    buffer_load_dwordx4 v[84:87], v9, s[40:43], s59 offen offset:1024 sc1
    s_waitcnt vmcnt(15) lgkmcnt(8)
    v_mfma_f32_32x32x16_bf16 v[144:159], v[224:227], v[40:43], v[144:159]
    ds_read_b64_tr_b16 v[216:217], v10 offset:9216
    ds_read_b64_tr_b16 v[218:219], v10 offset:11264
    v_add3_u32 v14, v40, v41, v14
    v_add3_u32 v14, v42, v43, v14
    v_mfma_f32_32x32x16_bf16 v[160:175], v[228:231], v[40:43], v[160:175]
    ds_read_b64_tr_b16 v[220:221], v11 offset:9216
    ds_read_b64_tr_b16 v[222:223], v11 offset:11264
    buffer_load_dwordx4 v[88:91], v9, s[40:43], s59 offen offset:2048 sc1
    s_waitcnt vmcnt(15) lgkmcnt(8)
    v_mfma_f32_32x32x16_bf16 v[144:159], v[232:235], v[44:47], v[144:159]
    ds_read_b64_tr_b16 v[224:225], v10 offset:12288
    ds_read_b64_tr_b16 v[226:227], v10 offset:14336
    v_add3_u32 v14, v44, v45, v14
    v_add3_u32 v14, v46, v47, v14
    v_mfma_f32_32x32x16_bf16 v[160:175], v[236:239], v[44:47], v[160:175]
    ds_read_b64_tr_b16 v[228:229], v11 offset:12288
    ds_read_b64_tr_b16 v[230:231], v11 offset:14336
    buffer_load_dwordx4 v[92:95], v9, s[40:43], s59 offen offset:3072 sc1
    s_waitcnt vmcnt(15) lgkmcnt(8)
    v_mfma_f32_32x32x16_bf16 v[144:159], v[208:211], v[48:51], v[144:159]
    ds_read_b64_tr_b16 v[232:233], v10 offset:13312
    ds_read_b64_tr_b16 v[234:235], v10 offset:15360
    v_add3_u32 v14, v48, v49, v14
    v_add3_u32 v14, v50, v51, v14
    v_mfma_f32_32x32x16_bf16 v[160:175], v[212:215], v[48:51], v[160:175]
    ds_read_b64_tr_b16 v[236:237], v11 offset:13312
    ds_read_b64_tr_b16 v[238:239], v11 offset:15360
    s_lshl1_add_u32 s59, s76, s69
    buffer_load_dwordx4 v[96:99], v9, s[40:43], s59 offen offset:0 sc1
    s_waitcnt vmcnt(15) lgkmcnt(8)
    v_mfma_f32_32x32x16_bf16 v[144:159], v[216:219], v[52:55], v[144:159]
    ds_read_b64_tr_b16 v[208:209], v10 offset:16384
    ds_read_b64_tr_b16 v[210:211], v10 offset:18432
    v_add3_u32 v14, v52, v53, v14
    v_add3_u32 v14, v54, v55, v14
    v_mfma_f32_32x32x16_bf16 v[160:175], v[220:223], v[52:55], v[160:175]
    ds_read_b64_tr_b16 v[212:213], v11 offset:16384
    ds_read_b64_tr_b16 v[214:215], v11 offset:18432
    buffer_load_dwordx4 v[100:103], v9, s[40:43], s59 offen offset:1024 sc1
    s_waitcnt vmcnt(15) lgkmcnt(8)
    v_mfma_f32_32x32x16_bf16 v[144:159], v[224:227], v[56:59], v[144:159]
    ds_read_b64_tr_b16 v[216:217], v10 offset:17408
    ds_read_b64_tr_b16 v[218:219], v10 offset:19456
    v_add3_u32 v14, v56, v57, v14
    v_add3_u32 v14, v58, v59, v14
    v_mfma_f32_32x32x16_bf16 v[160:175], v[228:231], v[56:59], v[160:175]
    ds_read_b64_tr_b16 v[220:221], v11 offset:17408
    ds_read_b64_tr_b16 v[222:223], v11 offset:19456
    buffer_load_dwordx4 v[104:107], v9, s[40:43], s59 offen offset:2048 sc1
    s_waitcnt vmcnt(15) lgkmcnt(8)
    v_mfma_f32_32x32x16_bf16 v[144:159], v[232:235], v[60:63], v[144:159]
    ds_read_b64_tr_b16 v[224:225], v10 offset:20480
    ds_read_b64_tr_b16 v[226:227], v10 offset:22528
    v_add3_u32 v14, v60, v61, v14
    v_add3_u32 v14, v62, v63, v14
    v_mfma_f32_32x32x16_bf16 v[160:175], v[236:239], v[60:63], v[160:175]
    ds_read_b64_tr_b16 v[228:229], v11 offset:20480
    ds_read_b64_tr_b16 v[230:231], v11 offset:22528
    buffer_load_dwordx4 v[108:111], v9, s[40:43], s59 offen offset:3072 sc1
    s_waitcnt vmcnt(15) lgkmcnt(8)
    v_mfma_f32_32x32x16_bf16 v[144:159], v[208:211], v[64:67], v[144:159]
    ds_read_b64_tr_b16 v[232:233], v10 offset:21504
    ds_read_b64_tr_b16 v[234:235], v10 offset:23552
    v_add3_u32 v14, v64, v65, v14
    v_add3_u32 v14, v66, v67, v14
    v_mfma_f32_32x32x16_bf16 v[160:175], v[212:215], v[64:67], v[160:175]
    ds_read_b64_tr_b16 v[236:237], v11 offset:21504
    ds_read_b64_tr_b16 v[238:239], v11 offset:23552
    s_lshl1_add_u32 s59, s77, s69
    buffer_load_dwordx4 v[112:115], v9, s[40:43], s59 offen offset:0 sc1
    s_waitcnt vmcnt(15) lgkmcnt(8)
    v_mfma_f32_32x32x16_bf16 v[144:159], v[216:219], v[68:71], v[144:159]
    ds_read_b64_tr_b16 v[208:209], v10 offset:24576
    ds_read_b64_tr_b16 v[210:211], v10 offset:26624
    v_add3_u32 v14, v68, v69, v14
    v_add3_u32 v14, v70, v71, v14
    v_mfma_f32_32x32x16_bf16 v[160:175], v[220:223], v[68:71], v[160:175]
    ds_read_b64_tr_b16 v[212:213], v11 offset:24576
    ds_read_b64_tr_b16 v[214:215], v11 offset:26624
    buffer_load_dwordx4 v[116:119], v9, s[40:43], s59 offen offset:1024 sc1
    s_waitcnt vmcnt(11) lgkmcnt(8)
    v_mfma_f32_32x32x16_bf16 v[144:159], v[224:227], v[72:75], v[144:159]
    ds_read_b64_tr_b16 v[216:217], v10 offset:25600
    ds_read_b64_tr_b16 v[218:219], v10 offset:27648
    v_add3_u32 v14, v72, v73, v14
    v_add3_u32 v14, v74, v75, v14
    v_mfma_f32_32x32x16_bf16 v[160:175], v[228:231], v[72:75], v[160:175]
    ds_read_b64_tr_b16 v[220:221], v11 offset:25600
    ds_read_b64_tr_b16 v[222:223], v11 offset:27648
    buffer_load_dwordx4 v[120:123], v9, s[40:43], s59 offen offset:2048 sc1
    s_waitcnt vmcnt(13)
    s_mov_b32 s67, 20000
    s_nop 6
L_sidew_12:
    v_xor_b32 v2, v194, v252
    v_xor_b32 v3, v198, v252
    v_or_b32 v2, v2, v3
    v_xor_b32 v3, v202, v252
    v_or_b32 v2, v2, v3
    v_xor_b32 v3, v206, v252
    v_or_b32 v2, v2, v3
    v_xor_b32 v3, v19, v252
    v_or_b32 v2, v2, v3
    v_xor_b32 v3, v23, v252
    v_or_b32 v2, v2, v3
    v_xor_b32 v3, v27, v252
    v_or_b32 v2, v2, v3
    v_xor_b32 v3, v31, v252
    v_or_b32 v2, v2, v3
    v_cmp_ne_u32 vcc, 0, v2
    s_nop 4
    s_cbranch_vccz L_sideok_13
    s_sub_u32 s67, s67, 1
    s_cbranch_scc1 L_sideok_13
    buffer_load_dwordx4 v[16:19], v15, s[40:43], s58 offen offset:0 sc1
    buffer_load_dwordx4 v[20:23], v15, s[40:43], s58 offen offset:512 sc1
    buffer_load_dwordx4 v[24:27], v15, s[40:43], s58 offen offset:1024 sc1
    buffer_load_dwordx4 v[28:31], v15, s[40:43], s58 offen offset:1536 sc1
    buffer_load_dwordx4 v[192:195], v9, s[40:43], s57 offen offset:0 sc1
    buffer_load_dwordx4 v[196:199], v9, s[40:43], s57 offen offset:1024 sc1
    buffer_load_dwordx4 v[200:203], v9, s[40:43], s57 offen offset:2048 sc1
    buffer_load_dwordx4 v[204:207], v15, s[40:43], s57 offen offset:3072 sc1
    s_waitcnt vmcnt(0)
    s_branch L_sidew_12
L_sideok_13:
    v_cmp_gt_u32 vcc, 32, v1
    s_nop 1
    v_cndmask_b32 v204, 0, v204, vcc
    s_waitcnt vmcnt(11) lgkmcnt(8)
    v_mfma_f32_32x32x16_bf16 v[144:159], v[232:235], v[76:79], v[144:159]
    ds_read_b64_tr_b16 v[224:225], v10 offset:28672
    ds_read_b64_tr_b16 v[226:227], v10 offset:30720
    v_add3_u32 v14, v76, v77, v14
    v_add3_u32 v14, v78, v79, v14
    v_mfma_f32_32x32x16_bf16 v[160:175], v[236:239], v[76:79], v[160:175]
    ds_read_b64_tr_b16 v[228:229], v11 offset:28672
    ds_read_b64_tr_b16 v[230:231], v11 offset:30720
    buffer_load_dwordx4 v[124:127], v9, s[40:43], s59 offen offset:3072 sc1
    v_cndmask_b32 v205, 0, v205, vcc
    v_add_f32 v192, v192, v196
    v_add_f32 v193, v193, v197
    s_waitcnt vmcnt(11) lgkmcnt(8)
    v_mfma_f32_32x32x16_bf16 v[144:159], v[208:211], v[80:83], v[144:159]
    ds_read_b64_tr_b16 v[232:233], v10 offset:29696
    ds_read_b64_tr_b16 v[234:235], v10 offset:31744
    v_add3_u32 v14, v80, v81, v14
    v_add3_u32 v14, v82, v83, v14
    v_mfma_f32_32x32x16_bf16 v[160:175], v[212:215], v[80:83], v[160:175]
    ds_read_b64_tr_b16 v[236:237], v11 offset:29696
    ds_read_b64_tr_b16 v[238:239], v11 offset:31744
    s_lshl1_add_u32 s59, s78, s69
    buffer_load_dwordx4 v[128:131], v9, s[40:43], s59 offen offset:0 sc1
    v_add_f32 v200, v200, v204
    v_add_f32 v201, v201, v205
    v_add_f32 v192, v192, v200
    s_waitcnt vmcnt(11) lgkmcnt(8)
    v_mfma_f32_32x32x16_bf16 v[144:159], v[216:219], v[84:87], v[144:159]
    ds_read_b64_tr_b16 v[208:209], v10 offset:32768
    ds_read_b64_tr_b16 v[210:211], v10 offset:34816
    v_add3_u32 v14, v84, v85, v14
    v_add3_u32 v14, v86, v87, v14
    v_mfma_f32_32x32x16_bf16 v[160:175], v[220:223], v[84:87], v[160:175]
    ds_read_b64_tr_b16 v[212:213], v11 offset:32768
    ds_read_b64_tr_b16 v[214:215], v11 offset:34816
    buffer_load_dwordx4 v[132:135], v9, s[40:43], s59 offen offset:1024 sc1
    v_add_f32 v193, v193, v201
    v_mov_b32 v19, 0
    v_mov_b32 v23, 0
    s_waitcnt vmcnt(11) lgkmcnt(8)
    v_mfma_f32_32x32x16_bf16 v[144:159], v[224:227], v[88:91], v[144:159]
    ds_read_b64_tr_b16 v[216:217], v10 offset:33792
    ds_read_b64_tr_b16 v[218:219], v10 offset:35840
    v_add3_u32 v14, v88, v89, v14
    v_add3_u32 v14, v90, v91, v14
    v_mfma_f32_32x32x16_bf16 v[160:175], v[228:231], v[88:91], v[160:175]
    ds_read_b64_tr_b16 v[220:221], v11 offset:33792
    ds_read_b64_tr_b16 v[222:223], v11 offset:35840
    buffer_load_dwordx4 v[136:139], v9, s[40:43], s59 offen offset:2048 sc1
    v_permlane32_swap_b32 v192, v193
    v_add_f32 v192, v192, v193
    v_mov_b32 v193, v192
    s_waitcnt vmcnt(11) lgkmcnt(8)
    v_mfma_f32_32x32x16_bf16 v[144:159], v[232:235], v[92:95], v[144:159]
    ds_read_b64_tr_b16 v[224:225], v10 offset:36864
    ds_read_b64_tr_b16 v[226:227], v10 offset:38912
    v_add3_u32 v14, v92, v93, v14
    v_add3_u32 v14, v94, v95, v14
    v_mfma_f32_32x32x16_bf16 v[160:175], v[236:239], v[92:95], v[160:175]
    ds_read_b64_tr_b16 v[228:229], v11 offset:36864
    ds_read_b64_tr_b16 v[230:231], v11 offset:38912
    buffer_load_dwordx4 v[140:143], v9, s[40:43], s59 offen offset:3072 sc1
    v_mov_b32 v27, 0
    v_mov_b32 v31, 0
    v_permlane32_swap_b32 v192, v193
    s_waitcnt vmcnt(11) lgkmcnt(8)
    v_mfma_f32_32x32x16_bf16 v[144:159], v[208:211], v[96:99], v[144:159]
    ds_read_b64_tr_b16 v[232:233], v10 offset:37888
    ds_read_b64_tr_b16 v[234:235], v10 offset:39936
    v_add3_u32 v14, v96, v97, v14
    v_add3_u32 v14, v98, v99, v14
    v_mfma_f32_32x32x16_bf16 v[160:175], v[212:215], v[96:99], v[160:175]
    ds_read_b64_tr_b16 v[236:237], v11 offset:37888
    ds_read_b64_tr_b16 v[238:239], v11 offset:39936
    s_waitcnt vmcnt(44)
    ds_read_b64_tr_b16 a[160:161], v5 offset:0
    ds_read_b64_tr_b16 a[162:163], v5 offset:1024
    ds_read_b64_tr_b16 a[164:165], v6 offset:0
    ds_read_b64_tr_b16 a[166:167], v6 offset:1024
    v_mul_f32 v192, 0xbb124925, v192
    v_mul_f32 v193, 0x3b124925, v193
    v_fma_f32 v193, -v192, v192, v193
    s_waitcnt vmcnt(10) lgkmcnt(12)
    v_mfma_f32_32x32x16_bf16 v[144:159], v[216:219], v[100:103], v[144:159]
    ds_read_b64_tr_b16 v[208:209], v10 offset:40960
    ds_read_b64_tr_b16 v[210:211], v10 offset:43008
    v_add3_u32 v14, v100, v101, v14
    v_add3_u32 v14, v102, v103, v14
    v_mfma_f32_32x32x16_bf16 v[160:175], v[220:223], v[100:103], v[160:175]
    ds_read_b64_tr_b16 v[212:213], v11 offset:40960
    ds_read_b64_tr_b16 v[214:215], v11 offset:43008
    s_waitcnt vmcnt(42)
    ds_read_b64_tr_b16 a[168:169], v5 offset:2048
    ds_read_b64_tr_b16 a[170:171], v5 offset:3072
    ds_read_b64_tr_b16 a[172:173], v6 offset:2048
    ds_read_b64_tr_b16 a[174:175], v6 offset:3072
    v_max_f32 v193, 0, v193
    v_add_f32 v194, 0x3727c5ac, v193
    v_sqrt_f32 v195, v194
    s_waitcnt vmcnt(9) lgkmcnt(15)
    v_mfma_f32_32x32x16_bf16 v[144:159], v[224:227], v[104:107], v[144:159]
    ds_read_b64_tr_b16 v[216:217], v10 offset:41984
    ds_read_b64_tr_b16 v[218:219], v10 offset:44032
    v_add3_u32 v14, v104, v105, v14
    v_add3_u32 v14, v106, v107, v14
    v_mfma_f32_32x32x16_bf16 v[160:175], v[228:231], v[104:107], v[160:175]
    ds_read_b64_tr_b16 v[220:221], v11 offset:41984
    ds_read_b64_tr_b16 v[222:223], v11 offset:44032
    s_waitcnt vmcnt(40)
    ds_read_b64_tr_b16 a[176:177], v5 offset:4096
    ds_read_b64_tr_b16 a[178:179], v5 offset:5120
    ds_read_b64_tr_b16 a[180:181], v6 offset:4096
    ds_read_b64_tr_b16 a[182:183], v6 offset:5120
    v_rcp_f32 v194, v194
    v_cvt_pk_bf16_f32 v244, v192, v192
    v_lshlrev_b32 v2, 16, v244
    s_waitcnt vmcnt(8) lgkmcnt(15)
    v_mfma_f32_32x32x16_bf16 v[144:159], v[232:235], v[108:111], v[144:159]
    ds_read_b64_tr_b16 v[224:225], v10 offset:45056
    ds_read_b64_tr_b16 v[226:227], v10 offset:47104
    v_add3_u32 v14, v108, v109, v14
    v_add3_u32 v14, v110, v111, v14
    v_mfma_f32_32x32x16_bf16 v[160:175], v[236:239], v[108:111], v[160:175]
    ds_read_b64_tr_b16 v[228:229], v11 offset:45056
    ds_read_b64_tr_b16 v[230:231], v11 offset:47104
    s_waitcnt vmcnt(38)
    ds_read_b64_tr_b16 a[184:185], v5 offset:6144
    ds_read_b64_tr_b16 a[186:187], v5 offset:7168
    ds_read_b64_tr_b16 a[188:189], v6 offset:6144
    ds_read_b64_tr_b16 a[190:191], v6 offset:7168
    v_sub_f32 v2, v192, v2
    v_cvt_pk_bf16_f32 v245, v2, v195
    v_and_b32 v2, 0xffff0000, v245
    s_waitcnt vmcnt(7) lgkmcnt(15)
    v_mfma_f32_32x32x16_bf16 v[144:159], v[208:211], v[112:115], v[144:159]
    ds_read_b64_tr_b16 v[232:233], v10 offset:46080
    ds_read_b64_tr_b16 v[234:235], v10 offset:48128
    v_add3_u32 v14, v112, v113, v14
    v_add3_u32 v14, v114, v115, v14
    v_mfma_f32_32x32x16_bf16 v[160:175], v[212:215], v[112:115], v[160:175]
    ds_read_b64_tr_b16 v[236:237], v11 offset:46080
    ds_read_b64_tr_b16 v[238:239], v11 offset:48128
    s_waitcnt lgkmcnt(15)
    s_mul_i32 s87, s75, 56
    s_add_u32 m0, s7, 0
    s_add_u32 s87, s87, s27
    s_add_u32 s87, s87, 86016
    buffer_load_dwordx4 v4, s[44:47], s87 offen offset:0 lds
    s_add_u32 s87, s87, 7168
    s_add_u32 m0, m0, 1024
    s_nop 0
    buffer_load_dwordx4 v4, s[44:47], s87 offen offset:0 lds
    v_sub_f32 v2, v195, v2
    v_cvt_pk_bf16_f32 v246, v2, 0
    v_cndmask_b32 v244, 0, v244, vcc
    s_waitcnt vmcnt(8) lgkmcnt(15)
    v_mfma_f32_32x32x16_bf16 v[144:159], v[216:219], v[116:119], v[144:159]
    ds_read_b64_tr_b16 v[208:209], v10 offset:49152
    ds_read_b64_tr_b16 v[210:211], v10 offset:51200
    v_add3_u32 v14, v116, v117, v14
    v_add3_u32 v14, v118, v119, v14
    v_mfma_f32_32x32x16_bf16 v[160:175], v[220:223], v[116:119], v[160:175]
    ds_read_b64_tr_b16 v[212:213], v11 offset:49152
    ds_read_b64_tr_b16 v[214:215], v11 offset:51200
    s_waitcnt lgkmcnt(15)
    s_mul_i32 s87, s76, 56
    s_add_u32 m0, s7, 2048
    s_add_u32 s87, s87, s27
    s_add_u32 s87, s87, 86016
    buffer_load_dwordx4 v4, s[44:47], s87 offen offset:0 lds
    s_add_u32 s87, s87, 7168
    s_add_u32 m0, m0, 1024
    s_nop 0
    buffer_load_dwordx4 v4, s[44:47], s87 offen offset:0 lds
    v_cndmask_b32 v245, 0, v245, vcc
    v_cndmask_b32 v246, 0, v246, vcc
    s_lshl_b32 s64, s52, 8
    s_waitcnt vmcnt(9) lgkmcnt(12)
    v_mfma_f32_32x32x16_bf16 v[144:159], v[224:227], v[120:123], v[144:159]
    ds_read_b64_tr_b16 v[216:217], v10 offset:50176
    ds_read_b64_tr_b16 v[218:219], v10 offset:52224
    v_add3_u32 v14, v120, v121, v14
    v_add3_u32 v14, v122, v123, v14
    v_mfma_f32_32x32x16_bf16 v[160:175], v[228:231], v[120:123], v[160:175]
    ds_read_b64_tr_b16 v[220:221], v11 offset:50176
    ds_read_b64_tr_b16 v[222:223], v11 offset:52224
    s_waitcnt lgkmcnt(15)
    s_mul_i32 s87, s77, 56
    s_add_u32 m0, s7, 4096
    s_add_u32 s87, s87, s27
    s_add_u32 s87, s87, 86016
    buffer_load_dwordx4 v4, s[44:47], s87 offen offset:0 lds
    s_add_u32 s87, s87, 7168
    s_add_u32 m0, m0, 1024
    s_nop 0
    buffer_load_dwordx4 v4, s[44:47], s87 offen offset:0 lds
    s_add_u32 s64, s64, 118784
    v_lshl_add_u32 v2, v1, 2, s64
    ds_write_b32 v2, v194
    s_waitcnt vmcnt(52)
    s_barrier
    s_waitcnt vmcnt(10) lgkmcnt(9)
    v_mfma_f32_32x32x16_bf16 v[144:159], v[232:235], v[124:127], v[144:159]
    ds_read_b64_tr_b16 v[224:225], v10 offset:53248
    ds_read_b64_tr_b16 v[226:227], v10 offset:55296
    v_add3_u32 v14, v124, v125, v14
    v_add3_u32 v14, v126, v127, v14
    v_mfma_f32_32x32x16_bf16 v[160:175], v[236:239], v[124:127], v[160:175]
    ds_read_b64_tr_b16 v[228:229], v11 offset:53248
    ds_read_b64_tr_b16 v[230:231], v11 offset:55296
    s_waitcnt lgkmcnt(15)
    s_mul_i32 s87, s78, 56
    s_add_u32 m0, s7, 6144
    s_add_u32 s87, s87, s27
    s_add_u32 s87, s87, 86016
    buffer_load_dwordx4 v4, s[44:47], s87 offen offset:0 lds
    s_add_u32 s87, s87, 7168
    s_add_u32 m0, m0, 1024
    s_nop 0
    buffer_load_dwordx4 v4, s[44:47], s87 offen offset:0 lds
    s_waitcnt vmcnt(11) lgkmcnt(9)
    v_mfma_f32_32x32x16_bf16 v[144:159], v[208:211], v[128:131], v[144:159]
    ds_read_b64_tr_b16 v[232:233], v10 offset:54272
    ds_read_b64_tr_b16 v[234:235], v10 offset:56320
    v_add3_u32 v14, v128, v129, v14
    v_add3_u32 v14, v130, v131, v14
    v_mfma_f32_32x32x16_bf16 v[160:175], v[212:215], v[128:131], v[160:175]
    ds_read_b64_tr_b16 v[236:237], v11 offset:54272
    ds_read_b64_tr_b16 v[238:239], v11 offset:56320
    s_waitcnt vmcnt(10) lgkmcnt(9)
    v_mfma_f32_32x32x16_bf16 v[144:159], v[216:219], v[132:135], v[144:159]
    v_add3_u32 v14, v132, v133, v14
    v_add3_u32 v14, v134, v135, v14
    v_mfma_f32_32x32x16_bf16 v[160:175], v[220:223], v[132:135], v[160:175]
    s_waitcnt vmcnt(9) lgkmcnt(4)
    v_mfma_f32_32x32x16_bf16 v[144:159], v[224:227], v[136:139], v[144:159]
    v_add3_u32 v14, v136, v137, v14
    v_add3_u32 v14, v138, v139, v14
    v_mfma_f32_32x32x16_bf16 v[160:175], v[228:231], v[136:139], v[160:175]
    s_waitcnt vmcnt(8) lgkmcnt(0)
    v_mfma_f32_32x32x16_bf16 v[144:159], v[232:235], v[140:143], v[144:159]
    v_add3_u32 v14, v140, v141, v14
    v_add3_u32 v14, v142, v143, v14
    v_mfma_f32_32x32x16_bf16 v[160:175], v[236:239], v[140:143], v[160:175]
    ds_read_b64_tr_b16 v[240:241], v12 offset:0
    ds_read_b64_tr_b16 v[242:243], v12 offset:2048
    ds_read_b64_tr_b16 v[208:209], v12 offset:1024
    ds_read_b64_tr_b16 v[210:211], v12 offset:3072
    ds_read_b64_tr_b16 v[212:213], v12 offset:4096
    ds_read_b64_tr_b16 v[214:215], v12 offset:6144
    ds_read_b64_tr_b16 v[216:217], v12 offset:5120
    ds_read_b64_tr_b16 v[218:219], v12 offset:7168
    ds_read_b64_tr_b16 v[220:221], v12 offset:8192
    ds_read_b64_tr_b16 v[222:223], v12 offset:10240
    v_mfma_f32_32x32x16_bf16 v[144:159], v[16:19], v[244:247], v[144:159]
    v_mfma_f32_32x32x16_bf16 v[160:175], v[20:23], v[244:247], v[160:175]
    s_nop 11
L_cont_d:
    v_mfma_f32_32x32x16_bf16 v[176:191], v[24:27], v[244:247], 0
    s_waitcnt lgkmcnt(8)
    v_mfma_f32_32x32x16_bf16 v[176:191], v[240:243], v[32:35], v[176:191]
    ds_read_b64_tr_b16 v[224:225], v12 offset:9216
    ds_read_b64_tr_b16 v[226:227], v12 offset:11264
    ds_read_b64_tr_b16 v[228:229], v12 offset:12288
    ds_read_b64_tr_b16 v[230:231], v12 offset:14336
    ds_read_b64_tr_b16 v[232:233], v12 offset:13312
    ds_read_b64_tr_b16 v[234:235], v12 offset:15360
    v_cmp_gt_u32 vcc, 56, v1
    v_mul_f32_e64 v144, v144, |v144|
    v_mul_f32_e64 v145, v145, |v145|
    v_mul_f32_e64 v146, v146, |v146|
    v_cndmask_b32 v3, 0, v249, vcc
    s_waitcnt lgkmcnt(12)
    v_mfma_f32_32x32x16_bf16 v[176:191], v[208:211], v[36:39], v[176:191]
    ds_read_b64_tr_b16 v[236:237], v12 offset:16384
    ds_read_b64_tr_b16 v[238:239], v12 offset:18432
    v_mul_f32_e64 v147, v147, |v147|
    v_mul_f32_e64 v148, v148, |v148|
    v_mul_f32_e64 v149, v149, |v149|
    v_sub_u32 v3, v14, v3
    v_mul_f32_e64 v150, v150, |v150|
    s_waitcnt lgkmcnt(12)
    v_mfma_f32_32x32x16_bf16 v[176:191], v[212:215], v[40:43], v[176:191]
    ds_read_b64_tr_b16 v[240:241], v12 offset:17408
    ds_read_b64_tr_b16 v[242:243], v12 offset:19456
    v_mul_f32_e64 v151, v151, |v151|
    v_cvt_pk_bf16_f32 v144, v144, v145
    v_add_u32_dpp v3, v3, v3 row_ror:8 row_mask:0xf bank_mask:0xf
    v_cvt_pk_bf16_f32 v145, v146, v147
    v_cvt_pk_bf16_f32 v146, v148, v149
    s_waitcnt lgkmcnt(12)
    v_mfma_f32_32x32x16_bf16 v[176:191], v[216:219], v[44:47], v[176:191]
    ds_read_b64_tr_b16 v[208:209], v12 offset:20480
    ds_read_b64_tr_b16 v[210:211], v12 offset:22528
    v_cvt_pk_bf16_f32 v147, v150, v151
    v_add_u32_dpp v3, v3, v3 row_ror:4 row_mask:0xf bank_mask:0xf
    v_pk_max_i16 v144, v144, 0
    v_pk_max_i16 v145, v145, 0
    v_pk_max_i16 v146, v146, 0
    s_waitcnt lgkmcnt(12)
    v_mfma_f32_32x32x16_bf16 v[176:191], v[220:223], v[48:51], v[176:191]
    ds_read_b64_tr_b16 v[212:213], v12 offset:21504
    ds_read_b64_tr_b16 v[214:215], v12 offset:23552
    v_add_u32_dpp v3, v3, v3 row_ror:2 row_mask:0xf bank_mask:0xf
    v_pk_max_i16 v147, v147, 0
    buffer_store_dwordx4 v[144:147], v9, s[40:43], s92 offen offset:0 sc1
    v_add_u32 v253, v144, v145
    v_add_u32_dpp v3, v3, v3 row_ror:1 row_mask:0xf bank_mask:0xf
    s_waitcnt lgkmcnt(12)
    v_mfma_f32_32x32x16_bf16 v[176:191], v[224:227], v[52:55], v[176:191]
    ds_read_b64_tr_b16 v[216:217], v12 offset:24576
    ds_read_b64_tr_b16 v[218:219], v12 offset:26624
    v_add3_u32 v253, v146, v147, v253
    v_mul_f32_e64 v152, v152, |v152|
    v_mul_f32_e64 v153, v153, |v153|
    v_readlane_b32 s64, v3, 0
    v_mul_f32_e64 v154, v154, |v154|
    s_waitcnt lgkmcnt(12)
    v_mfma_f32_32x32x16_bf16 v[176:191], v[228:231], v[56:59], v[176:191]
    ds_read_b64_tr_b16 v[220:221], v12 offset:25600
    ds_read_b64_tr_b16 v[222:223], v12 offset:27648
    v_mul_f32_e64 v155, v155, |v155|
    v_mul_f32_e64 v156, v156, |v156|
    v_readlane_b32 s65, v3, 16
    v_mul_f32_e64 v157, v157, |v157|
    v_mul_f32_e64 v158, v158, |v158|
    s_waitcnt lgkmcnt(12)
    v_mfma_f32_32x32x16_bf16 v[176:191], v[232:235], v[60:63], v[176:191]
    ds_read_b64_tr_b16 v[224:225], v12 offset:28672
    ds_read_b64_tr_b16 v[226:227], v12 offset:30720
    v_mul_f32_e64 v159, v159, |v159|
    v_readlane_b32 s66, v3, 32
    v_cvt_pk_bf16_f32 v148, v152, v153
    v_cvt_pk_bf16_f32 v149, v154, v155
    v_cvt_pk_bf16_f32 v150, v156, v157
    s_waitcnt lgkmcnt(12)
    v_mfma_f32_32x32x16_bf16 v[176:191], v[236:239], v[64:67], v[176:191]
    ds_read_b64_tr_b16 v[228:229], v12 offset:29696
    ds_read_b64_tr_b16 v[230:231], v12 offset:31744
    v_readlane_b32 s67, v3, 48
    v_cvt_pk_bf16_f32 v151, v158, v159
    v_pk_max_i16 v148, v148, 0
    v_pk_max_i16 v149, v149, 0
    s_add_u32 s64, s64, s65
    s_waitcnt lgkmcnt(12)
    v_mfma_f32_32x32x16_bf16 v[176:191], v[240:243], v[68:71], v[176:191]
    ds_read_b64_tr_b16 v[232:233], v12 offset:32768
    ds_read_b64_tr_b16 v[234:235], v12 offset:34816
    v_pk_max_i16 v150, v150, 0
    v_pk_max_i16 v151, v151, 0
    buffer_store_dwordx4 v[148:151], v9, s[40:43], s92 offen offset:1024 sc1
    s_add_u32 s66, s66, s67
    v_add_u32 v15, v148, v149
    s_waitcnt lgkmcnt(12)
    v_mfma_f32_32x32x16_bf16 v[176:191], v[208:211], v[72:75], v[176:191]
    ds_read_b64_tr_b16 v[236:237], v12 offset:33792
    ds_read_b64_tr_b16 v[238:239], v12 offset:35840
    v_add3_u32 v15, v150, v151, v15
    s_add_u32 s64, s64, s66
    s_cmp_eq_u32 s64, 0
    s_nop 6
    s_cbranch_scc1 L_vok_14
    s_sub_u32 s3, s3, 1
    s_cbranch_scc0 L_slow_d
L_vok_14:
    v_mov_b32 v14, v252
    v_add_u32_dpp v253, v253, v253 row_ror:8 row_mask:0xf bank_mask:0xf
    s_waitcnt lgkmcnt(12)
    v_mfma_f32_32x32x16_bf16 v[176:191], v[212:215], v[76:79], v[176:191]
    ds_read_b64_tr_b16 v[240:241], v12 offset:36864
    ds_read_b64_tr_b16 v[242:243], v12 offset:38912
    s_waitcnt vmcnt(8)
    ds_read_b64_tr_b16 a[192:193], v5 offset:0
    ds_read_b64_tr_b16 a[194:195], v5 offset:1024
    ds_read_b64_tr_b16 a[196:197], v6 offset:0
    ds_read_b64_tr_b16 a[198:199], v6 offset:1024
    v_add_u32_dpp v15, v15, v15 row_ror:8 row_mask:0xf bank_mask:0xf
    v_add_u32_dpp v253, v253, v253 row_ror:4 row_mask:0xf bank_mask:0xf
    s_nop 0
    v_add_u32_dpp v15, v15, v15 row_ror:4 row_mask:0xf bank_mask:0xf
    v_add_u32_dpp v253, v253, v253 row_ror:2 row_mask:0xf bank_mask:0xf
    s_nop 0
    v_add_u32_dpp v15, v15, v15 row_ror:2 row_mask:0xf bank_mask:0xf
    s_waitcnt lgkmcnt(15)
    v_mfma_f32_32x32x16_bf16 v[176:191], v[216:219], v[80:83], v[176:191]
    ds_read_b64_tr_b16 v[208:209], v12 offset:37888
    ds_read_b64_tr_b16 v[210:211], v12 offset:39936
    v_add_u32_dpp v253, v253, v253 row_ror:1 row_mask:0xf bank_mask:0xf
    v_add_u32_dpp v15, v15, v15 row_ror:1 row_mask:0xf bank_mask:0xf
    buffer_store_dwordx2 v[252:253], v0, s[40:43], s93 offen offset:0 sc1
    buffer_store_dwordx2 v[14:15], v0, s[40:43], s93 offen offset:2048 sc1
    s_add_u32 s93, s93, 4096
    s_waitcnt lgkmcnt(15)
    v_mfma_f32_32x32x16_bf16 v[176:191], v[220:223], v[84:87], v[176:191]
    ds_read_b64_tr_b16 v[212:213], v12 offset:40960
    ds_read_b64_tr_b16 v[214:215], v12 offset:43008
    v_mul_f32_e64 v160, v160, |v160|
    v_mul_f32_e64 v161, v161, |v161|
    v_mul_f32_e64 v162, v162, |v162|
    v_mul_f32_e64 v163, v163, |v163|
    s_waitcnt lgkmcnt(15)
    v_mfma_f32_32x32x16_bf16 v[176:191], v[224:227], v[88:91], v[176:191]
    ds_read_b64_tr_b16 v[216:217], v12 offset:41984
    ds_read_b64_tr_b16 v[218:219], v12 offset:44032
    v_mul_f32_e64 v164, v164, |v164|
    v_mul_f32_e64 v165, v165, |v165|
    v_mul_f32_e64 v166, v166, |v166|
    v_mul_f32_e64 v167, v167, |v167|
    v_cvt_pk_bf16_f32 v160, v160, v161
    s_waitcnt lgkmcnt(15)
    v_mfma_f32_32x32x16_bf16 v[176:191], v[228:231], v[92:95], v[176:191]
    ds_read_b64_tr_b16 v[220:221], v12 offset:45056
    ds_read_b64_tr_b16 v[222:223], v12 offset:47104
    s_waitcnt vmcnt(8)
    ds_read_b64_tr_b16 a[200:201], v5 offset:2048
    ds_read_b64_tr_b16 a[202:203], v5 offset:3072
    ds_read_b64_tr_b16 a[204:205], v6 offset:2048
    ds_read_b64_tr_b16 a[206:207], v6 offset:3072
    v_cvt_pk_bf16_f32 v161, v162, v163
    v_cvt_pk_bf16_f32 v162, v164, v165
    v_cvt_pk_bf16_f32 v163, v166, v167
    v_pk_max_i16 v160, v160, 0
    v_pk_max_i16 v161, v161, 0
    s_waitcnt lgkmcnt(15)
    v_mfma_f32_32x32x16_bf16 v[176:191], v[232:235], v[96:99], v[176:191]
    ds_read_b64_tr_b16 v[224:225], v12 offset:46080
    ds_read_b64_tr_b16 v[226:227], v12 offset:48128
    v_pk_max_i16 v162, v162, 0
    v_pk_max_i16 v163, v163, 0
    buffer_store_dwordx4 v[160:163], v9, s[40:43], s92 offen offset:2048 sc1
    v_add_u32 v253, v160, v161
    v_add3_u32 v253, v162, v163, v253
    s_waitcnt lgkmcnt(15)
    v_mfma_f32_32x32x16_bf16 v[176:191], v[236:239], v[100:103], v[176:191]
    ds_read_b64_tr_b16 v[228:229], v12 offset:49152
    ds_read_b64_tr_b16 v[230:231], v12 offset:51200
    v_mul_f32_e64 v168, v168, |v168|
    v_mul_f32_e64 v169, v169, |v169|
    v_mul_f32_e64 v170, v170, |v170|
    v_mul_f32_e64 v171, v171, |v171|
    v_mul_f32_e64 v172, v172, |v172|
    s_waitcnt lgkmcnt(15)
    v_mfma_f32_32x32x16_bf16 v[176:191], v[240:243], v[104:107], v[176:191]
    ds_read_b64_tr_b16 v[232:233], v12 offset:50176
    ds_read_b64_tr_b16 v[234:235], v12 offset:52224
    v_mul_f32_e64 v173, v173, |v173|
    v_mul_f32_e64 v174, v174, |v174|
    v_mul_f32_e64 v175, v175, |v175|
    v_cvt_pk_bf16_f32 v164, v168, v169
    v_cvt_pk_bf16_f32 v165, v170, v171
    s_waitcnt lgkmcnt(15)
    v_mfma_f32_32x32x16_bf16 v[176:191], v[208:211], v[108:111], v[176:191]
    ds_read_b64_tr_b16 v[236:237], v12 offset:53248
    ds_read_b64_tr_b16 v[238:239], v12 offset:55296
    s_waitcnt vmcnt(7)
    ds_read_b64_tr_b16 a[208:209], v5 offset:4096
    ds_read_b64_tr_b16 a[210:211], v5 offset:5120
    ds_read_b64_tr_b16 a[212:213], v6 offset:4096
    ds_read_b64_tr_b16 a[214:215], v6 offset:5120
    v_cvt_pk_bf16_f32 v166, v172, v173
    v_cvt_pk_bf16_f32 v167, v174, v175
    v_pk_max_i16 v164, v164, 0
    v_pk_max_i16 v165, v165, 0
    v_pk_max_i16 v166, v166, 0
    s_waitcnt lgkmcnt(15)
    v_mfma_f32_32x32x16_bf16 v[176:191], v[212:215], v[112:115], v[176:191]
    ds_read_b64_tr_b16 v[240:241], v12 offset:54272
    ds_read_b64_tr_b16 v[242:243], v12 offset:56320
    v_pk_max_i16 v167, v167, 0
    buffer_store_dwordx4 v[164:167], v9, s[40:43], s92 offen offset:3072 sc1
    v_add_u32 v15, v164, v165
    v_add3_u32 v15, v166, v167, v15
    v_add_u32_dpp v253, v253, v253 row_ror:8 row_mask:0xf bank_mask:0xf
    s_waitcnt lgkmcnt(15)
    v_mfma_f32_32x32x16_bf16 v[176:191], v[216:219], v[116:119], v[176:191]
    ds_read_b64_tr_b16 v[208:209], v13 offset:0
    ds_read_b64_tr_b16 v[210:211], v13 offset:2048
    v_add_u32_dpp v15, v15, v15 row_ror:8 row_mask:0xf bank_mask:0xf
    v_add_u32_dpp v253, v253, v253 row_ror:4 row_mask:0xf bank_mask:0xf
    s_nop 0
    v_add_u32_dpp v15, v15, v15 row_ror:4 row_mask:0xf bank_mask:0xf
    v_add_u32_dpp v253, v253, v253 row_ror:2 row_mask:0xf bank_mask:0xf
    s_nop 0
    v_add_u32_dpp v15, v15, v15 row_ror:2 row_mask:0xf bank_mask:0xf
    s_waitcnt lgkmcnt(15)
    v_mfma_f32_32x32x16_bf16 v[176:191], v[220:223], v[120:123], v[176:191]
    ds_read_b64_tr_b16 v[212:213], v13 offset:1024
    ds_read_b64_tr_b16 v[214:215], v13 offset:3072
    v_add_u32_dpp v253, v253, v253 row_ror:1 row_mask:0xf bank_mask:0xf
    v_add_u32_dpp v15, v15, v15 row_ror:1 row_mask:0xf bank_mask:0xf
    buffer_store_dwordx2 v[252:253], v0, s[40:43], s93 offen offset:0 sc1
    buffer_store_dwordx2 v[14:15], v0, s[40:43], s93 offen offset:2048 sc1
    s_add_u32 s93, s93, 4096
    s_waitcnt lgkmcnt(15)
    v_mfma_f32_32x32x16_bf16 v[176:191], v[224:227], v[124:127], v[176:191]
    ds_read_b64_tr_b16 v[216:217], v13 offset:4096
    ds_read_b64_tr_b16 v[218:219], v13 offset:6144
    s_waitcnt vmcnt(8)
    ds_read_b64_tr_b16 a[216:217], v5 offset:6144
    ds_read_b64_tr_b16 a[218:219], v5 offset:7168
    ds_read_b64_tr_b16 a[220:221], v6 offset:6144
    ds_read_b64_tr_b16 a[222:223], v6 offset:7168
    s_add_u32 s92, s92, 4096
    s_waitcnt lgkmcnt(15)
    v_mfma_f32_32x32x16_bf16 v[176:191], v[228:231], v[128:131], v[176:191]
    ds_read_b64_tr_b16 v[220:221], v13 offset:5120
    ds_read_b64_tr_b16 v[222:223], v13 offset:7168
    s_waitcnt lgkmcnt(15)
    v_mfma_f32_32x32x16_bf16 v[176:191], v[232:235], v[132:135], v[176:191]
    ds_read_b64_tr_b16 v[224:225], v13 offset:8192
    ds_read_b64_tr_b16 v[226:227], v13 offset:10240
    s_waitcnt lgkmcnt(15)
    v_mfma_f32_32x32x16_bf16 v[176:191], v[236:239], v[136:139], v[176:191]
    ds_read_b64_tr_b16 v[228:229], v13 offset:9216
    ds_read_b64_tr_b16 v[230:231], v13 offset:11264
    s_waitcnt lgkmcnt(15)
    v_mfma_f32_32x32x16_bf16 v[176:191], v[240:243], v[140:143], v[176:191]
    ds_read_b64_tr_b16 v[232:233], v13 offset:12288
    ds_read_b64_tr_b16 v[234:235], v13 offset:14336
    v_mfma_f32_32x32x16_bf16 v[192:207], v[28:31], v[244:247], 0
    s_waitcnt lgkmcnt(15)
    v_mfma_f32_32x32x16_bf16 v[192:207], v[208:211], v[32:35], v[192:207]
    ds_read_b64_tr_b16 v[236:237], v13 offset:13312
    ds_read_b64_tr_b16 v[238:239], v13 offset:15360
    s_lshl_b32 s68, s55, 14
    s_and_b32 s67, s52, 1
    s_lshl_b32 s64, s67, 11
    s_add_u32 s68, s68, s64
    s_mul_i32 s64, s5, 896
    s_waitcnt lgkmcnt(15)
    v_mfma_f32_32x32x16_bf16 v[192:207], v[212:215], v[36:39], v[192:207]
    ds_read_b64_tr_b16 v[240:241], v13 offset:16384
    ds_read_b64_tr_b16 v[242:243], v13 offset:18432
    s_add_u32 s68, s68, s64
    s_lshr_b32 s66, s52, 1
    s_mul_i32 s64, s66, 224
    s_add_u32 s68, s68, s64
    s_add_u32 s68, s68, 0xc30000
    s_waitcnt lgkmcnt(15)
    v_mfma_f32_32x32x16_bf16 v[192:207], v[216:219], v[40:43], v[192:207]
    ds_read_b64_tr_b16 v[208:209], v13 offset:17408
    ds_read_b64_tr_b16 v[210:211], v13 offset:19456
    v_min_u32 v2, 55, v1
    s_lshr_b32 s64, s72, 11
    v_lshrrev_b32 v250, 3, v2
    v_add_u32 v250, s64, v250
    v_subrev_u32 v3, 7, v250
    s_waitcnt lgkmcnt(12)
    v_mfma_f32_32x32x16_bf16 v[192:207], v[220:223], v[44:47], v[192:207]
    ds_read_b64_tr_b16 v[212:213], v13 offset:20480
    ds_read_b64_tr_b16 v[214:215], v13 offset:22528
    v_min_u32 v250, v250, v3
    v_bfe_u32 v3, v2, 2, 1
    v_xor_b32 v3, s66, v3
    v_mul_u32_u24 v3, 448, v3
    v_lshl_add_u32 v250, v250, 5, v3
    s_waitcnt lgkmcnt(12)
    v_mfma_f32_32x32x16_bf16 v[192:207], v[224:227], v[48:51], v[192:207]
    ds_read_b64_tr_b16 v[216:217], v13 offset:21504
    ds_read_b64_tr_b16 v[218:219], v13 offset:23552
    v_lshl_add_u32 v250, v255, 3, v250
    s_mul_i32 s69, s6, 114688
    s_mul_i32 s64, s66, 57344
    s_add_u32 s69, s69, s64
    s_lshl_b32 s64, s67, 10
    s_waitcnt lgkmcnt(12)
    v_mfma_f32_32x32x16_bf16 v[192:207], v[228:231], v[52:55], v[192:207]
    ds_read_b64_tr_b16 v[220:221], v13 offset:24576
    ds_read_b64_tr_b16 v[222:223], v13 offset:26624
    s_add_u32 s69, s69, s64
    s_add_u32 s69, s69, 0x500000
    s_mul_i32 s64, s66, 114688
    v_add_u32 v16, s64, v9
    s_sub_u32 s64, 114688, s64
    s_waitcnt lgkmcnt(12)
    v_mfma_f32_32x32x16_bf16 v[192:207], v[232:235], v[56:59], v[192:207]
    ds_read_b64_tr_b16 v[224:225], v13 offset:25600
    ds_read_b64_tr_b16 v[226:227], v13 offset:27648
    v_add_u32 v17, s64, v9
    v_mul_f32_e64 v176, v176, |v176|
    v_mul_f32_e64 v177, v177, |v177|
    v_mul_f32_e64 v178, v178, |v178|
    s_waitcnt lgkmcnt(12)
    v_mfma_f32_32x32x16_bf16 v[192:207], v[236:239], v[60:63], v[192:207]
    ds_read_b64_tr_b16 v[228:229], v13 offset:28672
    ds_read_b64_tr_b16 v[230:231], v13 offset:30720
    v_mul_f32_e64 v179, v179, |v179|
    v_mul_f32_e64 v180, v180, |v180|
    v_mul_f32_e64 v181, v181, |v181|
    v_mul_f32_e64 v182, v182, |v182|
    v_mul_f32_e64 v183, v183, |v183|
    s_waitcnt lgkmcnt(12)
    v_mfma_f32_32x32x16_bf16 v[192:207], v[240:243], v[64:67], v[192:207]
    ds_read_b64_tr_b16 v[232:233], v13 offset:29696
    ds_read_b64_tr_b16 v[234:235], v13 offset:31744
    v_cvt_pk_bf16_f32 v176, v176, v177
    v_cvt_pk_bf16_f32 v177, v178, v179
    v_cvt_pk_bf16_f32 v178, v180, v181
    v_cvt_pk_bf16_f32 v179, v182, v183
    v_pk_max_i16 v176, v176, 0
    s_waitcnt lgkmcnt(12)
    v_mfma_f32_32x32x16_bf16 v[192:207], v[208:211], v[68:71], v[192:207]
    ds_read_b64_tr_b16 v[236:237], v13 offset:32768
    ds_read_b64_tr_b16 v[238:239], v13 offset:34816
    v_pk_max_i16 v177, v177, 0
    v_pk_max_i16 v178, v178, 0
    v_pk_max_i16 v179, v179, 0
    buffer_store_dwordx4 v[176:179], v9, s[40:43], s92 offen offset:0 sc1
    v_add_u32 v253, v176, v177
    s_waitcnt lgkmcnt(12)
    v_mfma_f32_32x32x16_bf16 v[192:207], v[212:215], v[72:75], v[192:207]
    ds_read_b64_tr_b16 v[240:241], v13 offset:33792
    ds_read_b64_tr_b16 v[242:243], v13 offset:35840
    v_add3_u32 v253, v178, v179, v253
    v_mul_f32_e64 v184, v184, |v184|
    v_mul_f32_e64 v185, v185, |v185|
    v_mul_f32_e64 v186, v186, |v186|
    v_mul_f32_e64 v187, v187, |v187|
    s_waitcnt lgkmcnt(12)
    v_mfma_f32_32x32x16_bf16 v[192:207], v[216:219], v[76:79], v[192:207]
    ds_read_b64_tr_b16 v[208:209], v13 offset:36864
    ds_read_b64_tr_b16 v[210:211], v13 offset:38912
    v_mul_f32_e64 v188, v188, |v188|
    v_mul_f32_e64 v189, v189, |v189|
    v_mul_f32_e64 v190, v190, |v190|
    v_mul_f32_e64 v191, v191, |v191|
    v_cvt_pk_bf16_f32 v180, v184, v185
    s_waitcnt lgkmcnt(12)
    v_mfma_f32_32x32x16_bf16 v[192:207], v[220:223], v[80:83], v[192:207]
    ds_read_b64_tr_b16 v[212:213], v13 offset:37888
    ds_read_b64_tr_b16 v[214:215], v13 offset:39936
    v_cvt_pk_bf16_f32 v181, v186, v187
    v_cvt_pk_bf16_f32 v182, v188, v189
    v_cvt_pk_bf16_f32 v183, v190, v191
    v_pk_max_i16 v180, v180, 0
    v_pk_max_i16 v181, v181, 0
    s_waitcnt lgkmcnt(12)
    v_mfma_f32_32x32x16_bf16 v[192:207], v[224:227], v[84:87], v[192:207]
    ds_read_b64_tr_b16 v[216:217], v13 offset:40960
    ds_read_b64_tr_b16 v[218:219], v13 offset:43008
    v_pk_max_i16 v182, v182, 0
    v_pk_max_i16 v183, v183, 0
    buffer_store_dwordx4 v[180:183], v9, s[40:43], s92 offen offset:1024 sc1
    v_add_u32 v15, v180, v181
    v_add3_u32 v15, v182, v183, v15
    s_waitcnt lgkmcnt(12)
    v_mfma_f32_32x32x16_bf16 v[192:207], v[228:231], v[88:91], v[192:207]
    ds_read_b64_tr_b16 v[220:221], v13 offset:41984
    ds_read_b64_tr_b16 v[222:223], v13 offset:44032
    v_add_u32_dpp v253, v253, v253 row_ror:8 row_mask:0xf bank_mask:0xf
    v_add_u32_dpp v15, v15, v15 row_ror:8 row_mask:0xf bank_mask:0xf
    s_nop 0
    v_add_u32_dpp v253, v253, v253 row_ror:4 row_mask:0xf bank_mask:0xf
    v_add_u32_dpp v15, v15, v15 row_ror:4 row_mask:0xf bank_mask:0xf
    s_nop 0
    v_add_u32_dpp v253, v253, v253 row_ror:2 row_mask:0xf bank_mask:0xf
    s_waitcnt lgkmcnt(12)
    v_mfma_f32_32x32x16_bf16 v[192:207], v[232:235], v[92:95], v[192:207]
    ds_read_b64_tr_b16 v[224:225], v13 offset:45056
    ds_read_b64_tr_b16 v[226:227], v13 offset:47104
    v_add_u32_dpp v15, v15, v15 row_ror:2 row_mask:0xf bank_mask:0xf
    v_add_u32_dpp v253, v253, v253 row_ror:1 row_mask:0xf bank_mask:0xf
    s_nop 0
    v_add_u32_dpp v15, v15, v15 row_ror:1 row_mask:0xf bank_mask:0xf
    buffer_store_dwordx2 v[252:253], v0, s[40:43], s93 offen offset:0 sc1
    buffer_store_dwordx2 v[14:15], v0, s[40:43], s93 offen offset:2048 sc1
    s_waitcnt lgkmcnt(12)
    v_mfma_f32_32x32x16_bf16 v[192:207], v[236:239], v[96:99], v[192:207]
    ds_read_b64_tr_b16 v[228:229], v13 offset:46080
    ds_read_b64_tr_b16 v[230:231], v13 offset:48128
    s_add_u32 s93, s93, 4096
    s_waitcnt lgkmcnt(12)
    v_mfma_f32_32x32x16_bf16 v[192:207], v[240:243], v[100:103], v[192:207]
    ds_read_b64_tr_b16 v[232:233], v13 offset:49152
    ds_read_b64_tr_b16 v[234:235], v13 offset:51200
    s_waitcnt lgkmcnt(12)
    v_mfma_f32_32x32x16_bf16 v[192:207], v[208:211], v[104:107], v[192:207]
    ds_read_b64_tr_b16 v[236:237], v13 offset:50176
    ds_read_b64_tr_b16 v[238:239], v13 offset:52224
    s_waitcnt lgkmcnt(12)
    v_mfma_f32_32x32x16_bf16 v[192:207], v[212:215], v[108:111], v[192:207]
    ds_read_b64_tr_b16 v[240:241], v13 offset:53248
    ds_read_b64_tr_b16 v[242:243], v13 offset:55296
    s_waitcnt lgkmcnt(12)
    v_mfma_f32_32x32x16_bf16 v[192:207], v[216:219], v[112:115], v[192:207]
    ds_read_b64_tr_b16 v[208:209], v13 offset:54272
    ds_read_b64_tr_b16 v[210:211], v13 offset:56320
    s_waitcnt lgkmcnt(12)
    v_mfma_f32_32x32x16_bf16 v[192:207], v[220:223], v[116:119], v[192:207]
    s_waitcnt lgkmcnt(10)
    v_mfma_f32_32x32x16_bf16 v[192:207], v[224:227], v[120:123], v[192:207]
    s_waitcnt lgkmcnt(8)
    v_mfma_f32_32x32x16_bf16 v[192:207], v[228:231], v[124:127], v[192:207]
    s_waitcnt lgkmcnt(6)
    v_mfma_f32_32x32x16_bf16 v[192:207], v[232:235], v[128:131], v[192:207]
    s_waitcnt lgkmcnt(4)
    v_mfma_f32_32x32x16_bf16 v[192:207], v[236:239], v[132:135], v[192:207]
    s_waitcnt lgkmcnt(2)
    v_mfma_f32_32x32x16_bf16 v[192:207], v[240:243], v[136:139], v[192:207]
    s_waitcnt lgkmcnt(0)
    v_mfma_f32_32x32x16_bf16 v[192:207], v[208:211], v[140:143], v[192:207]
    s_nop 11
    v_mul_f32_e64 v192, v192, |v192|
    v_mul_f32_e64 v193, v193, |v193|
    v_mul_f32_e64 v194, v194, |v194|
    v_mul_f32_e64 v195, v195, |v195|
    v_mul_f32_e64 v196, v196, |v196|
    v_mul_f32_e64 v197, v197, |v197|
    v_mul_f32_e64 v198, v198, |v198|
    v_mul_f32_e64 v199, v199, |v199|
    v_cvt_pk_bf16_f32 v192, v192, v193
    v_cvt_pk_bf16_f32 v193, v194, v195
    v_cvt_pk_bf16_f32 v194, v196, v197
    v_cvt_pk_bf16_f32 v195, v198, v199
    v_pk_max_i16 v192, v192, 0
    v_pk_max_i16 v193, v193, 0
    v_pk_max_i16 v194, v194, 0
    v_pk_max_i16 v195, v195, 0
    buffer_store_dwordx4 v[192:195], v9, s[40:43], s92 offen offset:2048 sc1
    v_add_u32 v253, v192, v193
    v_add3_u32 v253, v194, v195, v253
    v_mul_f32_e64 v200, v200, |v200|
    v_mul_f32_e64 v201, v201, |v201|
    v_mul_f32_e64 v202, v202, |v202|
    v_mul_f32_e64 v203, v203, |v203|
    v_mul_f32_e64 v204, v204, |v204|
    v_mul_f32_e64 v205, v205, |v205|
    v_mul_f32_e64 v206, v206, |v206|
    v_mul_f32_e64 v207, v207, |v207|
    v_cvt_pk_bf16_f32 v196, v200, v201
    v_cvt_pk_bf16_f32 v197, v202, v203
    v_cvt_pk_bf16_f32 v198, v204, v205
    v_cvt_pk_bf16_f32 v199, v206, v207
    v_pk_max_i16 v196, v196, 0
    v_pk_max_i16 v197, v197, 0
    v_pk_max_i16 v198, v198, 0
    v_pk_max_i16 v199, v199, 0
    buffer_store_dwordx4 v[196:199], v9, s[40:43], s92 offen offset:3072 sc1
    v_add_u32 v15, v196, v197
    v_add3_u32 v15, v198, v199, v15
    v_add_u32_dpp v253, v253, v253 row_ror:8 row_mask:0xf bank_mask:0xf
    s_nop 0
    v_add_u32_dpp v15, v15, v15 row_ror:8 row_mask:0xf bank_mask:0xf
    v_add_u32_dpp v253, v253, v253 row_ror:4 row_mask:0xf bank_mask:0xf
    s_nop 0
    v_add_u32_dpp v15, v15, v15 row_ror:4 row_mask:0xf bank_mask:0xf
    v_add_u32_dpp v253, v253, v253 row_ror:2 row_mask:0xf bank_mask:0xf
    s_nop 0
    v_add_u32_dpp v15, v15, v15 row_ror:2 row_mask:0xf bank_mask:0xf
    v_add_u32_dpp v253, v253, v253 row_ror:1 row_mask:0xf bank_mask:0xf
    s_nop 0
    v_add_u32_dpp v15, v15, v15 row_ror:1 row_mask:0xf bank_mask:0xf
    buffer_store_dwordx2 v[252:253], v0, s[40:43], s93 offen offset:0 sc1
    buffer_store_dwordx2 v[14:15], v0, s[40:43], s93 offen offset:2048 sc1
    s_add_u32 s93, s93, 4096
    s_add_u32 s87, s68, 0
    buffer_load_dwordx2 v[248:249], v250, s[40:43], s87 offen sc1
    s_lshl2_add_u32 s57, s72, s69
    buffer_load_dwordx4 v[32:35], v16, s[40:43], s57 offen offset:0 sc1
    buffer_load_dwordx4 v[36:39], v17, s[40:43], s57 offen offset:0 sc1
    s_add_u32 s87, s68, 4096
    buffer_load_dwordx2 v[18:19], v250, s[40:43], s87 offen sc1
    s_lshl2_add_u32 s57, s72, s69
    buffer_load_dwordx4 v[88:91], v16, s[40:43], s57 offen offset:2048 sc1
    buffer_load_dwordx4 v[92:95], v17, s[40:43], s57 offen offset:2048 sc1
    s_lshl2_add_u32 s57, s73, s69
    buffer_load_dwordx4 v[40:43], v16, s[40:43], s57 offen offset:0 sc1
    buffer_load_dwordx4 v[44:47], v17, s[40:43], s57 offen offset:0 sc1
    s_lshl2_add_u32 s57, s74, s69
    buffer_load_dwordx4 v[48:51], v16, s[40:43], s57 offen offset:0 sc1
    buffer_load_dwordx4 v[52:55], v17, s[40:43], s57 offen offset:0 sc1
    s_lshl_b32 s64, s52, 11
    s_add_u32 s64, s64, 122880
    v_add_u32 v2, s64, v9
    ds_read_b128 v[224:227], v2
    ds_read_b128 v[228:231], v2 offset:1024
    v_mov_b32 v236, 0x3f80
    v_mov_b32 v237, 0
    v_mov_b32 v238, 0
    v_mov_b32 v239, 0
    s_xor_b32 s64, s52, 1
    s_mul_i32 s64, s64, 12288
    s_add_u32 s64, s64, 0
    v_add_u32 v243, s64, v9
    s_xor_b32 s64, s52, 2
    s_mul_i32 s64, s64, 12288
    s_add_u32 s64, s64, 4096
    v_add_u32 v244, s64, v9
    s_xor_b32 s64, s52, 3
    s_mul_i32 s64, s64, 12288
    s_add_u32 s64, s64, 8192
    v_add_u32 v245, s64, v9
    s_mul_i32 s64, s52, 12288
    s_add_u32 s64, s64, 0
    v_add_u32 v242, s64, v9
    s_waitcnt vmcnt(9)
    v_cmp_ne_u32 vcc, s26, v248
    s_nop 4
    s_cbranch_vccnz L_e_miss0
L_e_have0:
    s_waitcnt vmcnt(7)
    v_mfma_f32_32x32x16_bf16 v[144:159], a[0:3], v[32:35], 0
    v_add_u32 v22, v32, v33
    v_add3_u32 v22, v34, v35, v22
    s_waitcnt lgkmcnt(0)
    v_lshlrev_b32 v208, 16, v224
    v_mfma_f32_32x32x16_bf16 v[160:175], a[4:7], v[32:35], 0
    v_add3_u32 v22, v36, v37, v22
    v_add3_u32 v22, v38, v39, v22
    s_lshl2_add_u32 s57, s75, s69
    buffer_load_dwordx4 v[56:59], v16, s[40:43], s57 offen offset:0 sc1
    v_and_b32 v209, 0xffff0000, v224
    v_mfma_f32_32x32x16_bf16 v[176:191], a[0:3], v[36:39], 0
    buffer_load_dwordx4 v[60:63], v17, s[40:43], s57 offen offset:0 sc1
    v_lshlrev_b32 v210, 16, v225
    v_and_b32 v211, 0xffff0000, v225
    v_mfma_f32_32x32x16_bf16 v[192:207], a[4:7], v[36:39], 0
    s_lshl2_add_u32 s57, s76, s69
    buffer_load_dwordx4 v[64:67], v16, s[40:43], s57 offen offset:0 sc1
    v_lshlrev_b32 v216, 16, v226
    v_and_b32 v217, 0xffff0000, v226
    s_waitcnt vmcnt(5)
    v_mfma_f32_32x32x16_bf16 v[144:159], a[8:11], v[40:43], v[144:159]
    v_add3_u32 v22, v40, v41, v22
    v_add3_u32 v22, v42, v43, v22
    v_lshlrev_b32 v218, 16, v227
    v_and_b32 v219, 0xffff0000, v227
    v_mfma_f32_32x32x16_bf16 v[160:175], a[12:15], v[40:43], v[160:175]
    v_add3_u32 v22, v44, v45, v22
    v_add3_u32 v22, v46, v47, v22
    buffer_load_dwordx4 v[68:71], v17, s[40:43], s57 offen offset:0 sc1
    v_lshlrev_b32 v212, 16, v228
    v_mfma_f32_32x32x16_bf16 v[176:191], a[8:11], v[44:47], v[176:191]
    s_lshl2_add_u32 s57, s77, s69
    buffer_load_dwordx4 v[72:75], v16, s[40:43], s57 offen offset:0 sc1
    v_and_b32 v213, 0xffff0000, v228
    v_lshlrev_b32 v214, 16, v229
    v_mfma_f32_32x32x16_bf16 v[192:207], a[12:15], v[44:47], v[192:207]
    buffer_load_dwordx4 v[76:79], v17, s[40:43], s57 offen offset:0 sc1
    v_and_b32 v215, 0xffff0000, v229
    v_lshlrev_b32 v220, 16, v230
    s_waitcnt vmcnt(6)
    v_mfma_f32_32x32x16_bf16 v[144:159], a[16:19], v[48:51], v[144:159]
    v_add3_u32 v22, v48, v49, v22
    v_add3_u32 v22, v50, v51, v22
    v_and_b32 v221, 0xffff0000, v230
    v_lshlrev_b32 v222, 16, v231
    v_mfma_f32_32x32x16_bf16 v[160:175], a[20:23], v[48:51], v[160:175]
    v_add3_u32 v22, v52, v53, v22
    v_add3_u32 v22, v54, v55, v22
    s_lshl2_add_u32 s57, s78, s69
    buffer_load_dwordx4 v[80:83], v16, s[40:43], s57 offen offset:0 sc1
    v_and_b32 v223, 0xffff0000, v231
    v_mfma_f32_32x32x16_bf16 v[176:191], a[16:19], v[52:55], v[176:191]
    buffer_load_dwordx4 v[84:87], v17, s[40:43], s57 offen offset:0 sc1
    v_mul_u32_u24 v246, 896, v8
    v_lshl_add_u32 v246, v7, 4, v246
    v_mfma_f32_32x32x16_bf16 v[192:207], a[20:23], v[52:55], v[192:207]
    s_lshl2_add_u32 s57, s73, s69
    buffer_load_dwordx4 v[96:99], v16, s[40:43], s57 offen offset:2048 sc1
    s_lshr_b32 s64, s52, 1
    s_lshl_b32 s66, s5, 1
    s_waitcnt vmcnt(7)
    v_mfma_f32_32x32x16_bf16 v[144:159], a[24:27], v[56:59], v[144:159]
    v_add3_u32 v22, v56, v57, v22
    v_add3_u32 v22, v58, v59, v22
    s_add_u32 s64, s64, s66
    s_lshl_b32 s64, s64, 8
    v_mfma_f32_32x32x16_bf16 v[160:175], a[28:31], v[56:59], v[160:175]
    v_add3_u32 v22, v60, v61, v22
    v_add3_u32 v22, v62, v63, v22
    buffer_load_dwordx4 v[100:103], v17, s[40:43], s57 offen offset:2048 sc1
    s_add_u32 s64, s64, 118784
    v_mfma_f32_32x32x16_bf16 v[176:191], a[24:27], v[60:63], v[176:191]
    s_lshl2_add_u32 s57, s74, s69
    buffer_load_dwordx4 v[104:107], v16, s[40:43], s57 offen offset:2048 sc1
    v_lshl_add_u32 v241, v1, 2, s64
    v_mfma_f32_32x32x16_bf16 v[192:207], a[28:31], v[60:63], v[192:207]
    buffer_load_dwordx4 v[108:111], v17, s[40:43], s57 offen offset:2048 sc1
    s_waitcnt vmcnt(8)
    v_mfma_f32_32x32x16_bf16 v[144:159], a[32:35], v[64:67], v[144:159]
    v_add3_u32 v22, v64, v65, v22
    v_add3_u32 v22, v66, v67, v22
    v_mfma_f32_32x32x16_bf16 v[160:175], a[36:39], v[64:67], v[160:175]
    v_add3_u32 v22, v68, v69, v22
    v_add3_u32 v22, v70, v71, v22
    s_lshl2_add_u32 s57, s75, s69
    buffer_load_dwordx4 v[112:115], v16, s[40:43], s57 offen offset:2048 sc1
    v_mfma_f32_32x32x16_bf16 v[176:191], a[32:35], v[68:71], v[176:191]
    buffer_load_dwordx4 v[116:119], v17, s[40:43], s57 offen offset:2048 sc1
    v_mfma_f32_32x32x16_bf16 v[192:207], a[36:39], v[68:71], v[192:207]
    s_lshl2_add_u32 s57, s76, s69
    buffer_load_dwordx4 v[120:123], v16, s[40:43], s57 offen offset:2048 sc1
    s_waitcnt vmcnt(9)
    v_mfma_f32_32x32x16_bf16 v[144:159], a[40:43], v[72:75], v[144:159]
    v_add3_u32 v22, v72, v73, v22
    v_add3_u32 v22, v74, v75, v22
    v_mfma_f32_32x32x16_bf16 v[160:175], a[44:47], v[72:75], v[160:175]
    v_add3_u32 v22, v76, v77, v22
    v_add3_u32 v22, v78, v79, v22
    buffer_load_dwordx4 v[124:127], v17, s[40:43], s57 offen offset:2048 sc1
    v_mfma_f32_32x32x16_bf16 v[176:191], a[40:43], v[76:79], v[176:191]
    s_lshl2_add_u32 s57, s77, s69
    buffer_load_dwordx4 v[128:131], v16, s[40:43], s57 offen offset:2048 sc1
    v_mfma_f32_32x32x16_bf16 v[192:207], a[44:47], v[76:79], v[192:207]
    buffer_load_dwordx4 v[132:135], v17, s[40:43], s57 offen offset:2048 sc1
    s_waitcnt vmcnt(10)
    v_mfma_f32_32x32x16_bf16 v[144:159], a[48:51], v[80:83], v[144:159]
    v_add3_u32 v22, v80, v81, v22
    v_add3_u32 v22, v82, v83, v22
    v_mfma_f32_32x32x16_bf16 v[160:175], a[52:55], v[80:83], v[160:175]
    v_add3_u32 v22, v84, v85, v22
    v_add3_u32 v22, v86, v87, v22
    s_lshl2_add_u32 s57, s78, s69
    buffer_load_dwordx4 v[136:139], v16, s[40:43], s57 offen offset:2048 sc1
    v_mfma_f32_32x32x16_bf16 v[176:191], a[48:51], v[84:87], v[176:191]
    buffer_load_dwordx4 v[140:143], v17, s[40:43], s57 offen offset:2048 sc1
    v_mfma_f32_32x32x16_bf16 v[192:207], a[52:55], v[84:87], v[192:207]
    s_add_u32 s87, s68, 8192
    buffer_load_dwordx2 v[20:21], v250, s[40:43], s87 offen sc1
    v_mfma_f32_32x32x16_bf16 v[208:223], a[224:227], v[236:239], v[208:223]
    s_barrier
    ds_read_b32 v240, v241
    s_waitcnt vmcnt(27)
    v_cmp_ne_u32 vcc, s26, v18
    s_nop 7
    s_cbranch_vccnz L_e_miss1
L_e_have1:
    s_waitcnt vmcnt(25)
    v_mfma_f32_32x32x16_bf16 v[144:159], a[56:59], v[88:91], v[144:159]
    v_add3_u32 v22, v88, v89, v22
    v_add3_u32 v22, v90, v91, v22
    v_mfma_f32_32x32x16_bf16 v[160:175], a[60:63], v[88:91], v[160:175]
    v_add3_u32 v22, v92, v93, v22
    v_add3_u32 v22, v94, v95, v22
    s_lshl2_add_u32 s57, s72, s69
    s_add_u32 s57, s57, 4096
    buffer_load_dwordx4 v[32:35], v16, s[40:43], s57 offen offset:0 sc1
    v_mfma_f32_32x32x16_bf16 v[176:191], a[56:59], v[92:95], v[176:191]
    buffer_load_dwordx4 v[36:39], v17, s[40:43], s57 offen offset:0 sc1
    v_mfma_f32_32x32x16_bf16 v[192:207], a[60:63], v[92:95], v[192:207]
    s_lshl2_add_u32 s57, s73, s69
    s_add_u32 s57, s57, 4096
    buffer_load_dwordx4 v[40:43], v16, s[40:43], s57 offen offset:0 sc1
    s_waitcnt vmcnt(14)
    v_mfma_f32_32x32x16_bf16 v[144:159], a[64:67], v[96:99], v[144:159]
    v_add3_u32 v22, v96, v97, v22
    v_add3_u32 v22, v98, v99, v22
    v_mfma_f32_32x32x16_bf16 v[160:175], a[68:71], v[96:99], v[160:175]
    v_add3_u32 v22, v100, v101, v22
    v_add3_u32 v22, v102, v103, v22
    buffer_load_dwordx4 v[44:47], v17, s[40:43], s57 offen offset:0 sc1
    v_mfma_f32_32x32x16_bf16 v[176:191], a[64:67], v[100:103], v[176:191]
    s_lshl2_add_u32 s57, s74, s69
    s_add_u32 s57, s57, 4096
    buffer_load_dwordx4 v[48:51], v16, s[40:43], s57 offen offset:0 sc1
    v_mfma_f32_32x32x16_bf16 v[192:207], a[68:71], v[100:103], v[192:207]
    buffer_load_dwordx4 v[52:55], v17, s[40:43], s57 offen offset:0 sc1
    s_waitcnt vmcnt(15)
    v_mfma_f32_32x32x16_bf16 v[144:159], a[72:75], v[104:107], v[144:159]
    v_add3_u32 v22, v104, v105, v22
    v_add3_u32 v22, v106, v107, v22
    v_mfma_f32_32x32x16_bf16 v[160:175], a[76:79], v[104:107], v[160:175]
    v_add3_u32 v22, v108, v109, v22
    v_add3_u32 v22, v110, v111, v22
    s_lshl2_add_u32 s57, s75, s69
    s_add_u32 s57, s57, 4096
    buffer_load_dwordx4 v[56:59], v16, s[40:43], s57 offen offset:0 sc1
    v_mfma_f32_32x32x16_bf16 v[176:191], a[72:75], v[108:111], v[176:191]
    buffer_load_dwordx4 v[60:63], v17, s[40:43], s57 offen offset:0 sc1
    v_mfma_f32_32x32x16_bf16 v[192:207], a[76:79], v[108:111], v[192:207]
    s_waitcnt vmcnt(15)
    v_mfma_f32_32x32x16_bf16 v[144:159], a[80:83], v[112:115], v[144:159]
    v_add3_u32 v22, v112, v113, v22
    v_add3_u32 v22, v114, v115, v22
    v_mfma_f32_32x32x16_bf16 v[160:175], a[84:87], v[112:115], v[160:175]
    v_add3_u32 v22, v116, v117, v22
    v_add3_u32 v22, v118, v119, v22
    s_lshl2_add_u32 s57, s76, s69
    s_add_u32 s57, s57, 4096
    buffer_load_dwordx4 v[64:67], v16, s[40:43], s57 offen offset:0 sc1
    v_mfma_f32_32x32x16_bf16 v[176:191], a[80:83], v[116:119], v[176:191]
    buffer_load_dwordx4 v[68:71], v17, s[40:43], s57 offen offset:0 sc1
    v_mfma_f32_32x32x16_bf16 v[192:207], a[84:87], v[116:119], v[192:207]
    s_waitcnt vmcnt(15)
    v_mfma_f32_32x32x16_bf16 v[144:159], a[88:91], v[120:123], v[144:159]
    v_add3_u32 v22, v120, v121, v22
    v_add3_u32 v22, v122, v123, v22
    v_mfma_f32_32x32x16_bf16 v[160:175], a[92:95], v[120:123], v[160:175]
    v_add3_u32 v22, v124, v125, v22
    v_add3_u32 v22, v126, v127, v22
    s_lshl2_add_u32 s57, s77, s69
    s_add_u32 s57, s57, 4096
    buffer_load_dwordx4 v[72:75], v16, s[40:43], s57 offen offset:0 sc1
    v_mfma_f32_32x32x16_bf16 v[176:191], a[88:91], v[124:127], v[176:191]
    buffer_load_dwordx4 v[76:79], v17, s[40:43], s57 offen offset:0 sc1
    v_mfma_f32_32x32x16_bf16 v[192:207], a[92:95], v[124:127], v[192:207]
    s_waitcnt vmcnt(15)
    v_mfma_f32_32x32x16_bf16 v[144:159], a[96:99], v[128:131], v[144:159]
    v_add3_u32 v22, v128, v129, v22
    v_add3_u32 v22, v130, v131, v22
    v_mfma_f32_32x32x16_bf16 v[160:175], a[100:103], v[128:131], v[160:175]
    v_add3_u32 v22, v132, v133, v22
    v_add3_u32 v22, v134, v135, v22
    s_lshl2_add_u32 s57, s78, s69
    s_add_u32 s57, s57, 4096
    buffer_load_dwordx4 v[80:83], v16, s[40:43], s57 offen offset:0 sc1
    v_mfma_f32_32x32x16_bf16 v[176:191], a[96:99], v[132:135], v[176:191]
    buffer_load_dwordx4 v[84:87], v17, s[40:43], s57 offen offset:0 sc1
    v_mfma_f32_32x32x16_bf16 v[192:207], a[100:103], v[132:135], v[192:207]
    s_waitcnt vmcnt(15)
    v_mfma_f32_32x32x16_bf16 v[144:159], a[104:107], v[136:139], v[144:159]
    v_add3_u32 v22, v136, v137, v22
    v_add3_u32 v22, v138, v139, v22
    v_mfma_f32_32x32x16_bf16 v[160:175], a[108:111], v[136:139], v[160:175]
    v_add3_u32 v22, v140, v141, v22
    v_add3_u32 v22, v142, v143, v22
    s_add_u32 s87, s68, 12288
    buffer_load_dwordx2 v[24:25], v250, s[40:43], s87 offen sc1
    v_mfma_f32_32x32x16_bf16 v[176:191], a[104:107], v[140:143], v[176:191]
    s_lshl2_add_u32 s57, s72, s69
    s_add_u32 s57, s57, 4096
    buffer_load_dwordx4 v[88:91], v16, s[40:43], s57 offen offset:2048 sc1
    v_mfma_f32_32x32x16_bf16 v[192:207], a[108:111], v[140:143], v[192:207]
    buffer_load_dwordx4 v[92:95], v17, s[40:43], s57 offen offset:2048 sc1
    s_waitcnt vmcnt(17)
    v_cmp_ne_u32 vcc, s26, v20
    s_nop 8
    s_cbranch_vccnz L_e_miss2
L_e_have2:
    s_waitcnt vmcnt(15)
    v_mfma_f32_32x32x16_bf16 v[144:159], a[112:115], v[32:35], v[144:159]
    v_add3_u32 v22, v32, v33, v22
    v_add3_u32 v22, v34, v35, v22
    v_mfma_f32_32x32x16_bf16 v[160:175], a[116:119], v[32:35], v[160:175]
    v_add3_u32 v22, v36, v37, v22
    v_add3_u32 v22, v38, v39, v22
    s_lshl2_add_u32 s57, s73, s69
    s_add_u32 s57, s57, 4096
    buffer_load_dwordx4 v[96:99], v16, s[40:43], s57 offen offset:2048 sc1
    v_mfma_f32_32x32x16_bf16 v[176:191], a[112:115], v[36:39], v[176:191]
    buffer_load_dwordx4 v[100:103], v17, s[40:43], s57 offen offset:2048 sc1
    v_mfma_f32_32x32x16_bf16 v[192:207], a[116:119], v[36:39], v[192:207]
    s_waitcnt vmcnt(15)
    v_mfma_f32_32x32x16_bf16 v[144:159], a[120:123], v[40:43], v[144:159]
    v_add3_u32 v22, v40, v41, v22
    v_add3_u32 v22, v42, v43, v22
    v_mfma_f32_32x32x16_bf16 v[160:175], a[124:127], v[40:43], v[160:175]
    v_add3_u32 v22, v44, v45, v22
    v_add3_u32 v22, v46, v47, v22
    s_lshl2_add_u32 s57, s74, s69
    s_add_u32 s57, s57, 4096
    buffer_load_dwordx4 v[104:107], v16, s[40:43], s57 offen offset:2048 sc1
    v_mfma_f32_32x32x16_bf16 v[176:191], a[120:123], v[44:47], v[176:191]
    buffer_load_dwordx4 v[108:111], v17, s[40:43], s57 offen offset:2048 sc1
    v_mfma_f32_32x32x16_bf16 v[192:207], a[124:127], v[44:47], v[192:207]
    s_waitcnt vmcnt(15)
    v_mfma_f32_32x32x16_bf16 v[144:159], a[128:131], v[48:51], v[144:159]
    v_add3_u32 v22, v48, v49, v22
    v_add3_u32 v22, v50, v51, v22
    v_mfma_f32_32x32x16_bf16 v[160:175], a[132:135], v[48:51], v[160:175]
    v_add3_u32 v22, v52, v53, v22
    v_add3_u32 v22, v54, v55, v22
    s_lshl2_add_u32 s57, s75, s69
    s_add_u32 s57, s57, 4096
    buffer_load_dwordx4 v[112:115], v16, s[40:43], s57 offen offset:2048 sc1
    v_mfma_f32_32x32x16_bf16 v[176:191], a[128:131], v[52:55], v[176:191]
    buffer_load_dwordx4 v[116:119], v17, s[40:43], s57 offen offset:2048 sc1
    v_mfma_f32_32x32x16_bf16 v[192:207], a[132:135], v[52:55], v[192:207]
    s_waitcnt vmcnt(15)
    v_mfma_f32_32x32x16_bf16 v[144:159], a[136:139], v[56:59], v[144:159]
    v_add3_u32 v22, v56, v57, v22
    v_add3_u32 v22, v58, v59, v22
    v_mfma_f32_32x32x16_bf16 v[160:175], a[140:143], v[56:59], v[160:175]
    v_add3_u32 v22, v60, v61, v22
    v_add3_u32 v22, v62, v63, v22
    s_lshl2_add_u32 s57, s76, s69
    s_add_u32 s57, s57, 4096
    buffer_load_dwordx4 v[120:123], v16, s[40:43], s57 offen offset:2048 sc1
    v_mfma_f32_32x32x16_bf16 v[176:191], a[136:139], v[60:63], v[176:191]
    buffer_load_dwordx4 v[124:127], v17, s[40:43], s57 offen offset:2048 sc1
    v_mfma_f32_32x32x16_bf16 v[192:207], a[140:143], v[60:63], v[192:207]
    s_waitcnt vmcnt(15)
    v_mfma_f32_32x32x16_bf16 v[144:159], a[144:147], v[64:67], v[144:159]
    v_add3_u32 v22, v64, v65, v22
    v_add3_u32 v22, v66, v67, v22
    v_mfma_f32_32x32x16_bf16 v[160:175], a[148:151], v[64:67], v[160:175]
    v_add3_u32 v22, v68, v69, v22
    v_add3_u32 v22, v70, v71, v22
    s_lshl2_add_u32 s57, s77, s69
    s_add_u32 s57, s57, 4096
    buffer_load_dwordx4 v[128:131], v16, s[40:43], s57 offen offset:2048 sc1
    v_mfma_f32_32x32x16_bf16 v[176:191], a[144:147], v[68:71], v[176:191]
    buffer_load_dwordx4 v[132:135], v17, s[40:43], s57 offen offset:2048 sc1
    v_mfma_f32_32x32x16_bf16 v[192:207], a[148:151], v[68:71], v[192:207]
    s_waitcnt vmcnt(15)
    v_mfma_f32_32x32x16_bf16 v[144:159], a[152:155], v[72:75], v[144:159]
    v_add3_u32 v22, v72, v73, v22
    v_add3_u32 v22, v74, v75, v22
    v_mfma_f32_32x32x16_bf16 v[160:175], a[156:159], v[72:75], v[160:175]
    v_add3_u32 v22, v76, v77, v22
    v_add3_u32 v22, v78, v79, v22
    s_lshl2_add_u32 s57, s78, s69
    s_add_u32 s57, s57, 4096
    buffer_load_dwordx4 v[136:139], v16, s[40:43], s57 offen offset:2048 sc1
    v_mfma_f32_32x32x16_bf16 v[176:191], a[152:155], v[76:79], v[176:191]
    buffer_load_dwordx4 v[140:143], v17, s[40:43], s57 offen offset:2048 sc1
    v_mfma_f32_32x32x16_bf16 v[192:207], a[156:159], v[76:79], v[192:207]
    s_waitcnt vmcnt(15)
    v_mfma_f32_32x32x16_bf16 v[144:159], a[160:163], v[80:83], v[144:159]
    v_add3_u32 v22, v80, v81, v22
    v_add3_u32 v22, v82, v83, v22
    v_mfma_f32_32x32x16_bf16 v[160:175], a[164:167], v[80:83], v[160:175]
    v_add3_u32 v22, v84, v85, v22
    v_add3_u32 v22, v86, v87, v22
    v_mfma_f32_32x32x16_bf16 v[176:191], a[160:163], v[84:87], v[176:191]
    v_mfma_f32_32x32x16_bf16 v[192:207], a[164:167], v[84:87], v[192:207]
    s_waitcnt vmcnt(14)
    v_cmp_ne_u32 vcc, s26, v24
    s_nop 9
    s_cbranch_vccnz L_e_miss3
L_e_have3:
    s_waitcnt vmcnt(12)
    v_mfma_f32_32x32x16_bf16 v[160:175], a[172:175], v[88:91], v[160:175]
    v_add3_u32 v22, v88, v89, v22
    v_add3_u32 v22, v90, v91, v22
    v_add3_u32 v22, v92, v93, v22
    v_add3_u32 v22, v94, v95, v22
    s_waitcnt vmcnt(10)
    v_mfma_f32_32x32x16_bf16 v[160:175], a[180:183], v[96:99], v[160:175]
    v_add3_u32 v22, v96, v97, v22
    v_add3_u32 v22, v98, v99, v22
    v_add3_u32 v22, v100, v101, v22
    v_add3_u32 v22, v102, v103, v22
    s_waitcnt vmcnt(8)
    v_mfma_f32_32x32x16_bf16 v[160:175], a[188:191], v[104:107], v[160:175]
    v_add3_u32 v22, v104, v105, v22
    v_add3_u32 v22, v106, v107, v22
    v_add3_u32 v22, v108, v109, v22
    v_add3_u32 v22, v110, v111, v22
    s_waitcnt vmcnt(6)
    v_mfma_f32_32x32x16_bf16 v[160:175], a[196:199], v[112:115], v[160:175]
    v_add3_u32 v22, v112, v113, v22
    v_add3_u32 v22, v114, v115, v22
    v_add3_u32 v22, v116, v117, v22
    v_add3_u32 v22, v118, v119, v22
    s_waitcnt vmcnt(4)
    v_mfma_f32_32x32x16_bf16 v[160:175], a[204:207], v[120:123], v[160:175]
    v_add3_u32 v22, v120, v121, v22
    v_add3_u32 v22, v122, v123, v22
    v_add3_u32 v22, v124, v125, v22
    v_add3_u32 v22, v126, v127, v22
    s_waitcnt vmcnt(2)
    v_mfma_f32_32x32x16_bf16 v[160:175], a[212:215], v[128:131], v[160:175]
    v_add3_u32 v22, v128, v129, v22
    v_add3_u32 v22, v130, v131, v22
    v_add3_u32 v22, v132, v133, v22
    v_add3_u32 v22, v134, v135, v22
    s_waitcnt vmcnt(0)
    v_mfma_f32_32x32x16_bf16 v[160:175], a[220:223], v[136:139], v[160:175]
    v_add3_u32 v22, v136, v137, v22
    v_add3_u32 v22, v138, v139, v22
    v_add3_u32 v22, v140, v141, v22
    v_add3_u32 v22, v142, v143, v22
    s_nop 7
L_cont_e:
    v_mfma_f32_32x32x16_bf16 v[176:191], a[168:171], v[92:95], v[176:191]
    v_cmp_gt_u32 vcc, 56, v1
    v_add3_u32 v3, v249, v19, v21
    v_add_u32 v3, v3, v25
    v_mfma_f32_32x32x16_bf16 v[176:191], a[176:179], v[100:103], v[176:191]
    v_cndmask_b32 v3, 0, v3, vcc
    v_sub_u32 v3, v22, v3
    s_nop 1
    v_add_u32_dpp v3, v3, v3 row_ror:8 row_mask:0xf bank_mask:0xf
    v_mfma_f32_32x32x16_bf16 v[176:191], a[184:187], v[108:111], v[176:191]
    ds_write_b128 v243, v[160:163] offset:0
    v_add_u32_dpp v3, v3, v3 row_ror:4 row_mask:0xf bank_mask:0xf
    s_nop 1
    v_add_u32_dpp v3, v3, v3 row_ror:2 row_mask:0xf bank_mask:0xf
    s_nop 1
    v_add_u32_dpp v3, v3, v3 row_ror:1 row_mask:0xf bank_mask:0xf
    v_mfma_f32_32x32x16_bf16 v[176:191], a[192:195], v[116:119], v[176:191]
    ds_write_b128 v243, v[164:167] offset:1024
    v_readlane_b32 s64, v3, 0
    v_readlane_b32 s65, v3, 16
    v_readlane_b32 s66, v3, 32
    v_mfma_f32_32x32x16_bf16 v[176:191], a[200:203], v[124:127], v[176:191]
    ds_write_b128 v243, v[168:171] offset:2048
    v_readlane_b32 s67, v3, 48
    s_add_u32 s64, s64, s65
    s_add_u32 s66, s66, s67
    v_mfma_f32_32x32x16_bf16 v[176:191], a[208:211], v[132:135], v[176:191]
    ds_write_b128 v243, v[172:175] offset:3072
    s_add_u32 s64, s64, s66
    s_cmp_eq_u32 s64, 0
    s_nop 8
    s_cbranch_scc1 L_vok_15
    s_sub_u32 s3, s3, 1
    s_cbranch_scc0 L_slow_e
L_vok_15:
    v_mfma_f32_32x32x16_bf16 v[176:191], a[216:219], v[140:143], v[176:191]
    v_mfma_f32_32x32x16_bf16 v[192:207], a[172:175], v[92:95], v[192:207]
    s_mov_b32 s48, s20
    s_mov_b32 s49, s21
    s_mov_b32 s50, 0x1c0000
    v_mfma_f32_32x32x16_bf16 v[192:207], a[180:183], v[100:103], v[192:207]
    s_mov_b32 s51, 0x20000
    s_lshr_b32 s59, s52, 1
    s_add_u32 s59, s59, s6
    v_mfma_f32_32x32x16_bf16 v[192:207], a[188:191], v[108:111], v[192:207]
    s_nop 2
    ds_write_b128 v244, v[176:179] offset:0
    s_mul_i32 s59, s59, 28672
    s_add_u32 s59, s59, s4
    s_and_b32 s60, s52, 1
    v_mfma_f32_32x32x16_bf16 v[192:207], a[196:199], v[116:119], v[192:207]
    ds_write_b128 v244, v[180:183] offset:1024
    s_lshl_b32 s60, s60, 6
    s_add_u32 s59, s59, s60
    v_mfma_f32_32x32x16_bf16 v[192:207], a[204:207], v[124:127], v[192:207]
    ds_write_b128 v244, v[184:187] offset:2048
    v_mfma_f32_32x32x16_bf16 v[192:207], a[212:215], v[132:135], v[192:207]
    ds_write_b128 v244, v[188:191] offset:3072
    v_mfma_f32_32x32x16_bf16 v[192:207], a[220:223], v[140:143], v[192:207]
    v_mfma_f32_32x32x16_bf16 v[144:159], a[168:171], v[88:91], v[144:159]
    v_mfma_f32_32x32x16_bf16 v[144:159], a[176:179], v[96:99], v[144:159]
    v_mfma_f32_32x32x16_bf16 v[144:159], a[184:187], v[104:107], v[144:159]
    s_nop 8
    ds_write_b128 v245, v[192:195] offset:0
    v_mfma_f32_32x32x16_bf16 v[144:159], a[192:195], v[112:115], v[144:159]
    ds_write_b128 v245, v[196:199] offset:1024
    v_mfma_f32_32x32x16_bf16 v[144:159], a[200:203], v[120:123], v[144:159]
    ds_write_b128 v245, v[200:203] offset:2048
    v_mfma_f32_32x32x16_bf16 v[144:159], a[208:211], v[128:131], v[144:159]
    ds_write_b128 v245, v[204:207] offset:3072
    v_mfma_f32_32x32x16_bf16 v[144:159], a[216:219], v[136:139], v[144:159]
    s_waitcnt lgkmcnt(0)
    s_barrier
    ds_read_b128 v[32:35], v242 offset:0
    ds_read_b128 v[48:51], v242 offset:4096
    ds_read_b128 v[64:67], v242 offset:8192
    ds_read_b128 v[36:39], v242 offset:1024
    ds_read_b128 v[52:55], v242 offset:5120
    ds_read_b128 v[68:71], v242 offset:9216
    ds_read_b128 v[40:43], v242 offset:2048
    ds_read_b128 v[56:59], v242 offset:6144
    ds_read_b128 v[72:75], v242 offset:10240
    ds_read_b128 v[44:47], v242 offset:3072
    ds_read_b128 v[60:63], v242 offset:7168
    ds_read_b128 v[76:79], v242 offset:11264
    s_waitcnt lgkmcnt(9)
    v_pk_add_f32 v[32:33], v[32:33], v[48:49]
    v_pk_add_f32 v[144:145], v[144:145], v[64:65]
    v_pk_add_f32 v[34:35], v[34:35], v[50:51]
    v_pk_add_f32 v[146:147], v[146:147], v[66:67]
    v_pk_add_f32 v[144:145], v[144:145], v[32:33]
    v_pk_add_f32 v[146:147], v[146:147], v[34:35]
    v_pk_fma_f32 v[144:145], v[144:145], v[240:241], v[208:209] op_sel_hi:[1,0,1]
    v_pk_fma_f32 v[146:147], v[146:147], v[240:241], v[210:211] op_sel_hi:[1,0,1]
    v_cvt_pk_bf16_f32 v96, v144, v145
    v_cvt_pk_bf16_f32 v97, v146, v147
    s_waitcnt lgkmcnt(6)
    v_pk_add_f32 v[36:37], v[36:37], v[52:53]
    v_pk_add_f32 v[148:149], v[148:149], v[68:69]
    v_pk_add_f32 v[38:39], v[38:39], v[54:55]
    v_pk_add_f32 v[150:151], v[150:151], v[70:71]
    v_pk_add_f32 v[148:149], v[148:149], v[36:37]
    v_pk_add_f32 v[150:151], v[150:151], v[38:39]
    v_pk_fma_f32 v[148:149], v[148:149], v[240:241], v[212:213] op_sel_hi:[1,0,1]
    v_pk_fma_f32 v[150:151], v[150:151], v[240:241], v[214:215] op_sel_hi:[1,0,1]
    v_cvt_pk_bf16_f32 v98, v148, v149
    v_cvt_pk_bf16_f32 v99, v150, v151
    s_nop 0
    v_permlane32_swap_b32 v96, v98
    v_permlane32_swap_b32 v97, v99
    buffer_store_dwordx4 v[96:99], v246, s[48:51], s59 offen offset:0
    s_waitcnt lgkmcnt(3)
    v_pk_add_f32 v[40:41], v[40:41], v[56:57]
    v_pk_add_f32 v[152:153], v[152:153], v[72:73]
    v_pk_add_f32 v[42:43], v[42:43], v[58:59]
    v_pk_add_f32 v[154:155], v[154:155], v[74:75]
    v_pk_add_f32 v[152:153], v[152:153], v[40:41]
    v_pk_add_f32 v[154:155], v[154:155], v[42:43]
    v_pk_fma_f32 v[152:153], v[152:153], v[240:241], v[216:217] op_sel_hi:[1,0,1]
    v_pk_fma_f32 v[154:155], v[154:155], v[240:241], v[218:219] op_sel_hi:[1,0,1]
    v_cvt_pk_bf16_f32 v100, v152, v153
    v_cvt_pk_bf16_f32 v101, v154, v155
    s_waitcnt lgkmcnt(0)
    v_pk_add_f32 v[44:45], v[44:45], v[60:61]
    v_pk_add_f32 v[156:157], v[156:157], v[76:77]
    v_pk_add_f32 v[46:47], v[46:47], v[62:63]
    v_pk_add_f32 v[158:159], v[158:159], v[78:79]
    v_pk_add_f32 v[156:157], v[156:157], v[44:45]
    v_pk_add_f32 v[158:159], v[158:159], v[46:47]
    v_pk_fma_f32 v[156:157], v[156:157], v[240:241], v[220:221] op_sel_hi:[1,0,1]
    v_pk_fma_f32 v[158:159], v[158:159], v[240:241], v[222:223] op_sel_hi:[1,0,1]
    v_cvt_pk_bf16_f32 v102, v156, v157
    v_cvt_pk_bf16_f32 v103, v158, v159
    s_nop 0
    v_permlane32_swap_b32 v100, v102
    v_permlane32_swap_b32 v101, v103
    buffer_store_dwordx4 v[100:103], v246, s[48:51], s59 offen offset:32
    s_nop 3
L_fin:
L_end:
    s_endpgm
L_spare:
    s_lshl_b32 s64, s55, 1
    s_add_u32 s64, s64, s56
    s_sub_u32 s64, s64, 14
    s_lshl_b32 s64, s64, 2
    s_add_u32 s64, s64, s52
    s_cmp_ge_u32 s64, 112
    s_cbranch_scc1 L_sp2
    s_mov_b32 s32, s12
    s_mov_b32 s33, s13
    s_mov_b32 s34, 0x188000
    s_mov_b32 s35, 0x20000
    s_mov_b32 s48, s14
    s_mov_b32 s49, s15
    s_mov_b32 s50, 0xe00
    s_mov_b32 s51, 0x20000
    s_lshl_b32 s65, s64, 5
    v_lshrrev_b32 v2, 1, v1
    v_mul_u32_u24 v2, 3584, v2
    v_and_b32 v3, 1, v1
    v_lshl_add_u32 v2, v3, 4, v2
    s_mov_b32 s66, s65
    buffer_load_dwordx4 v[32:35], v2, s[32:35], s66 offen
    s_add_u32 s66, s66, 114688
    buffer_load_dwordx4 v[36:39], v2, s[32:35], s66 offen
    s_add_u32 s66, s66, 114688
    buffer_load_dwordx4 v[40:43], v2, s[32:35], s66 offen
    s_add_u32 s66, s66, 114688
    buffer_load_dwordx4 v[44:47], v2, s[32:35], s66 offen
    s_add_u32 s66, s66, 114688
    buffer_load_dwordx4 v[48:51], v2, s[32:35], s66 offen
    s_add_u32 s66, s66, 114688
    buffer_load_dwordx4 v[52:55], v2, s[32:35], s66 offen
    s_add_u32 s66, s66, 114688
    buffer_load_dwordx4 v[56:59], v2, s[32:35], s66 offen
    s_add_u32 s66, s66, 114688
    buffer_load_dwordx4 v[60:63], v2, s[32:35], s66 offen
    s_add_u32 s66, s66, 114688
    buffer_load_dwordx4 v[64:67], v2, s[32:35], s66 offen
    s_add_u32 s66, s66, 114688
    buffer_load_dwordx4 v[68:71], v2, s[32:35], s66 offen
    s_add_u32 s66, s66, 114688
    buffer_load_dwordx4 v[72:75], v2, s[32:35], s66 offen
    s_add_u32 s66, s66, 114688
    buffer_load_dwordx4 v[76:79], v2, s[32:35], s66 offen
    s_add_u32 s66, s66, 114688
    buffer_load_dwordx4 v[80:83], v2, s[32:35], s66 offen
    s_add_u32 s66, s66, 114688
    buffer_load_dwordx4 v[84:87], v2, s[32:35], s66 offen
    v_lshlrev_b32 v10, 3, v3
    v_bfe_u32 v2, v1, 4, 1
    v_lshl_add_u32 v10, v2, 2, v10
    v_bfe_u32 v2, v1, 1, 2
    v_add_u32 v10, v10, v2
    v_lshlrev_b32 v2, 1, v10
    buffer_load_ushort v104, v2, s[48:51], s65 offen
    v_and_b32 v2, 15, v1
    v_mov_b32 v3, 0x3f80
    v_mov_b32 v11, 0x3f800000
    v_cmp_eq_u32 vcc, 0, v2
    s_nop 1
    v_cndmask_b32 v96, 0, v3, vcc
    v_cmp_eq_u32 vcc, 1, v2
    s_nop 1
    v_cndmask_b32 v96, v96, v11, vcc
    v_cmp_eq_u32 vcc, 2, v2
    s_nop 1
    v_cndmask_b32 v97, 0, v3, vcc
    v_cmp_eq_u32 vcc, 3, v2
    s_nop 1
    v_cndmask_b32 v97, v97, v11, vcc
    v_cmp_eq_u32 vcc, 4, v2
    s_nop 1
    v_cndmask_b32 v98, 0, v3, vcc
    v_cmp_eq_u32 vcc, 5, v2
    s_nop 1
    v_cndmask_b32 v98, v98, v11, vcc
    v_cmp_eq_u32 vcc, 6, v2
    s_nop 1
    v_cndmask_b32 v99, 0, v3, vcc
    v_cmp_eq_u32 vcc, 7, v2
    s_nop 1
    v_cndmask_b32 v99, v99, v11, vcc
    s_waitcnt vmcnt(14)
    s_nop 0
    v_mfma_f32_16x16x32_bf16 v[100:103], v[96:99], v[32:35], 0
    s_waitcnt vmcnt(13)
    v_mfma_f32_16x16x32_bf16 v[100:103], v[96:99], v[36:39], v[100:103]
    s_waitcnt vmcnt(12)
    v_mfma_f32_16x16x32_bf16 v[100:103], v[96:99], v[40:43], v[100:103]
    s_waitcnt vmcnt(11)
    v_mfma_f32_16x16x32_bf16 v[100:103], v[96:99], v[44:47], v[100:103]
    s_waitcnt vmcnt(10)
    v_mfma_f32_16x16x32_bf16 v[100:103], v[96:99], v[48:51], v[100:103]
    s_waitcnt vmcnt(9)
    v_mfma_f32_16x16x32_bf16 v[100:103], v[96:99], v[52:55], v[100:103]
    s_waitcnt vmcnt(8)
    v_mfma_f32_16x16x32_bf16 v[100:103], v[96:99], v[56:59], v[100:103]
    s_waitcnt vmcnt(7)
    v_mfma_f32_16x16x32_bf16 v[100:103], v[96:99], v[60:63], v[100:103]
    s_waitcnt vmcnt(6)
    v_mfma_f32_16x16x32_bf16 v[100:103], v[96:99], v[64:67], v[100:103]
    s_waitcnt vmcnt(5)
    v_mfma_f32_16x16x32_bf16 v[100:103], v[96:99], v[68:71], v[100:103]
    s_waitcnt vmcnt(4)
    v_mfma_f32_16x16x32_bf16 v[100:103], v[96:99], v[72:75], v[100:103]
    s_waitcnt vmcnt(3)
    v_mfma_f32_16x16x32_bf16 v[100:103], v[96:99], v[76:79], v[100:103]
    s_waitcnt vmcnt(2)
    v_mfma_f32_16x16x32_bf16 v[100:103], v[96:99], v[80:83], v[100:103]
    s_waitcnt vmcnt(1)
    v_mfma_f32_16x16x32_bf16 v[100:103], v[96:99], v[84:87], v[100:103]
    s_nop 7
    v_add_f32_dpp v100, v100, v100 row_ror:2 row_mask:0xf bank_mask:0xf
    v_add_f32_dpp v101, v101, v101 row_ror:2 row_mask:0xf bank_mask:0xf
    v_add_f32_dpp v102, v102, v102 row_ror:2 row_mask:0xf bank_mask:0xf
    v_add_f32_dpp v103, v103, v103 row_ror:2 row_mask:0xf bank_mask:0xf
    v_add_f32_dpp v100, v100, v100 row_ror:4 row_mask:0xf bank_mask:0xf
    v_add_f32_dpp v101, v101, v101 row_ror:4 row_mask:0xf bank_mask:0xf
    v_add_f32_dpp v102, v102, v102 row_ror:4 row_mask:0xf bank_mask:0xf
    v_add_f32_dpp v103, v103, v103 row_ror:4 row_mask:0xf bank_mask:0xf
    v_add_f32_dpp v100, v100, v100 row_ror:8 row_mask:0xf bank_mask:0xf
    v_add_f32_dpp v101, v101, v101 row_ror:8 row_mask:0xf bank_mask:0xf
    v_add_f32_dpp v102, v102, v102 row_ror:8 row_mask:0xf bank_mask:0xf
    v_add_f32_dpp v103, v103, v103 row_ror:8 row_mask:0xf bank_mask:0xf
    s_mov_b32 s100, 0xcccccccc
    s_mov_b32 s101, 0xcccccccc
    v_cndmask_b32 v100, v100, v101, s[100:101]
    v_cndmask_b32 v102, v102, v103, s[100:101]
    s_mov_b32 s100, 0xf0f0f0f0
    s_mov_b32 s101, 0xf0f0f0f0
    v_cndmask_b32 v100, v100, v102, s[100:101]
    v_cvt_pk_bf16_f32 v109, v100, 0
    v_lshlrev_b32 v2, 16, v109
    v_sub_f32 v2, v100, v2
    v_cvt_pk_bf16_f32 v108, v100, v2
    s_waitcnt vmcnt(0)
    v_lshl_or_b32 v109, v104, 16, v109
    v_mov_b32 v110, v104
    v_mov_b32 v111, v252
    v_lshlrev_b32 v2, 4, v10
    s_lshl_b32 s65, s64, 8
    s_add_u32 s65, s65, 0xcc0000
    s_mov_b64 exec, 0xffffffff
    buffer_store_dwordx4 v[108:111], v2, s[40:43], s65 offen sc1
    s_mov_b64 exec, -1
    s_nop 0
L_sp2:
    s_mov_b32 s88, s16
    s_mov_b32 s89, s17
    s_mov_b32 s90, 0x188000
    s_mov_b32 s91, 0x20000
    s_bfe_u32 s65, s2, 0x20003
    s_lshl2_add_u32 s65, s65, s52
    s_mul_i32 s65, s65, 196
    v_cmp_gt_u32 vcc, 49, v1
    v_mov_b32 v116, 0x40000000
    v_add_u32 v2, s65, v1
    v_mul_u32_u24 v3, 9363, v2
    v_lshrrev_b32 v3, 21, v3
    v_mul_u32_u24 v3, 86016, v3
    v_lshl_add_u32 v2, v2, 7, v3
    v_cndmask_b32 v112, v116, v2, vcc
    s_add_u32 s65, s65, 49
    v_add_u32 v2, s65, v1
    v_mul_u32_u24 v3, 9363, v2
    v_lshrrev_b32 v3, 21, v3
    v_mul_u32_u24 v3, 86016, v3
    v_lshl_add_u32 v2, v2, 7, v3
    v_cndmask_b32 v113, v116, v2, vcc
    s_add_u32 s65, s65, 49
    v_add_u32 v2, s65, v1
    v_mul_u32_u24 v3, 9363, v2
    v_lshrrev_b32 v3, 21, v3
    v_mul_u32_u24 v3, 86016, v3
    v_lshl_add_u32 v2, v2, 7, v3
    v_cndmask_b32 v114, v116, v2, vcc
    s_add_u32 s65, s65, 49
    v_add_u32 v2, s65, v1
    v_mul_u32_u24 v3, 9363, v2
    v_lshrrev_b32 v3, 21, v3
    v_mul_u32_u24 v3, 86016, v3
    v_lshl_add_u32 v2, v2, 7, v3
    v_cndmask_b32 v115, v116, v2, vcc
    s_add_u32 s65, s65, 49
    s_mov_b32 s65, 57344
    buffer_load_dword v117, v112, s[88:91], s65 offen
    buffer_load_dword v117, v113, s[88:91], s65 offen
    buffer_load_dword v117, v114, s[88:91], s65 offen
    buffer_load_dword v117, v115, s[88:91], s65 offen
    s_mov_b32 s65, 86016
    buffer_load_dword v117, v112, s[88:91], s65 offen
    buffer_load_dword v117, v113, s[88:91], s65 offen
    buffer_load_dword v117, v114, s[88:91], s65 offen
    buffer_load_dword v117, v115, s[88:91], s65 offen
    s_waitcnt vmcnt(0)
    s_branch L_fin
L_again:
    s_mov_b32 s67, 20000
L_again2:
    s_mov_b64 s[100:101], vcc
    buffer_load_dwordx2 v[248:249], v15, s[40:43], s68 offen sc1
    s_and_b32 s64, s100, 0xffff
    s_cbranch_scc0 L_pk_16
    s_xor_b32 s59, s69, 0
    buffer_load_dwordx4 v[32:35], v9, s[40:43], s59 offen offset:0 sc1
    buffer_load_dwordx4 v[36:39], v9, s[40:43], s59 offen offset:1024 sc1
    buffer_load_dwordx4 v[40:43], v9, s[40:43], s59 offen offset:2048 sc1
    buffer_load_dwordx4 v[44:47], v9, s[40:43], s59 offen offset:3072 sc1
L_pk_16:
    s_lshr_b32 s64, s100, 16
    s_cbranch_scc0 L_pk_17
    s_xor_b32 s59, s69, 4096
    buffer_load_dwordx4 v[48:51], v9, s[40:43], s59 offen offset:0 sc1
    buffer_load_dwordx4 v[52:55], v9, s[40:43], s59 offen offset:1024 sc1
    buffer_load_dwordx4 v[56:59], v9, s[40:43], s59 offen offset:2048 sc1
    buffer_load_dwordx4 v[60:63], v9, s[40:43], s59 offen offset:3072 sc1
L_pk_17:
    s_and_b32 s64, s101, 0xffff
    s_cbranch_scc0 L_pk_18
    s_xor_b32 s59, s69, 8192
    buffer_load_dwordx4 v[64:67], v9, s[40:43], s59 offen offset:0 sc1
    buffer_load_dwordx4 v[68:71], v9, s[40:43], s59 offen offset:1024 sc1
    buffer_load_dwordx4 v[72:75], v9, s[40:43], s59 offen offset:2048 sc1
    buffer_load_dwordx4 v[76:79], v9, s[40:43], s59 offen offset:3072 sc1
L_pk_18:
    s_lshr_b32 s64, s101, 16
    s_cbranch_scc0 L_pk_19
    s_xor_b32 s59, s69, 12288
    buffer_load_dwordx4 v[80:83], v9, s[40:43], s59 offen offset:0 sc1
    buffer_load_dwordx4 v[84:87], v9, s[40:43], s59 offen offset:1024 sc1
    buffer_load_dwordx4 v[88:91], v9, s[40:43], s59 offen offset:2048 sc1
    buffer_load_dwordx4 v[92:95], v9, s[40:43], s59 offen offset:3072 sc1
L_pk_19:
    s_waitcnt vmcnt(0)
    v_cmp_ne_u32 vcc, s26, v248
    s_nop 4
    s_cbranch_vccz L_allp
    s_sub_u32 s67, s67, 1
    s_cbranch_scc0 L_again2
    s_branch L_allp
L_slow_b2:
    s_xor_b32 s59, s69, 0
    buffer_load_dwordx4 v[32:35], v9, s[40:43], s59 offen offset:0 sc1
    buffer_load_dwordx4 v[36:39], v9, s[40:43], s59 offen offset:1024 sc1
    buffer_load_dwordx4 v[40:43], v9, s[40:43], s59 offen offset:2048 sc1
    buffer_load_dwordx4 v[44:47], v9, s[40:43], s59 offen offset:3072 sc1
    s_xor_b32 s59, s69, 4096
    buffer_load_dwordx4 v[48:51], v9, s[40:43], s59 offen offset:0 sc1
    buffer_load_dwordx4 v[52:55], v9, s[40:43], s59 offen offset:1024 sc1
    buffer_load_dwordx4 v[56:59], v9, s[40:43], s59 offen offset:2048 sc1
    buffer_load_dwordx4 v[60:63], v9, s[40:43], s59 offen offset:3072 sc1
    s_xor_b32 s59, s69, 8192
    buffer_load_dwordx4 v[64:67], v9, s[40:43], s59 offen offset:0 sc1
    buffer_load_dwordx4 v[68:71], v9, s[40:43], s59 offen offset:1024 sc1
    buffer_load_dwordx4 v[72:75], v9, s[40:43], s59 offen offset:2048 sc1
    buffer_load_dwordx4 v[76:79], v9, s[40:43], s59 offen offset:3072 sc1
    s_xor_b32 s59, s69, 12288
    buffer_load_dwordx4 v[80:83], v9, s[40:43], s59 offen offset:0 sc1
    buffer_load_dwordx4 v[84:87], v9, s[40:43], s59 offen offset:1024 sc1
    buffer_load_dwordx4 v[88:91], v9, s[40:43], s59 offen offset:2048 sc1
    buffer_load_dwordx4 v[92:95], v9, s[40:43], s59 offen offset:3072 sc1
    s_waitcnt vmcnt(15)
    v_mfma_f32_32x32x16_bf16 v[100:115], v[192:195], v[32:35], 0
    v_add_u32 v14, v32, v33
    v_add3_u32 v14, v34, v35, v14
    s_waitcnt vmcnt(14)
    v_mfma_f32_32x32x16_bf16 v[100:115], v[192:195], v[36:39], v[100:115]
    v_add3_u32 v14, v36, v37, v14
    v_add3_u32 v14, v38, v39, v14
    s_waitcnt vmcnt(13)
    v_mfma_f32_32x32x16_bf16 v[100:115], v[192:195], v[40:43], v[100:115]
    v_add3_u32 v14, v40, v41, v14
    v_add3_u32 v14, v42, v43, v14
    s_waitcnt vmcnt(12)
    v_mfma_f32_32x32x16_bf16 v[100:115], v[192:195], v[44:47], v[100:115]
    v_add3_u32 v14, v44, v45, v14
    v_add3_u32 v14, v46, v47, v14
    s_waitcnt vmcnt(11)
    v_mfma_f32_32x32x16_bf16 v[100:115], v[192:195], v[48:51], v[100:115]
    v_add3_u32 v14, v48, v49, v14
    v_add3_u32 v14, v50, v51, v14
    s_waitcnt vmcnt(10)
    v_mfma_f32_32x32x16_bf16 v[100:115], v[192:195], v[52:55], v[100:115]
    v_add3_u32 v14, v52, v53, v14
    v_add3_u32 v14, v54, v55, v14
    s_waitcnt vmcnt(9)
    v_mfma_f32_32x32x16_bf16 v[100:115], v[192:195], v[56:59], v[100:115]
    v_add3_u32 v14, v56, v57, v14
    v_add3_u32 v14, v58, v59, v14
    s_waitcnt vmcnt(8)
    v_mfma_f32_32x32x16_bf16 v[100:115], v[192:195], v[60:63], v[100:115]
    v_add3_u32 v14, v60, v61, v14
    v_add3_u32 v14, v62, v63, v14
    s_waitcnt vmcnt(7)
    v_mfma_f32_32x32x16_bf16 v[100:115], v[192:195], v[64:67], v[100:115]
    v_add3_u32 v14, v64, v65, v14
    v_add3_u32 v14, v66, v67, v14
    s_waitcnt vmcnt(6)
    v_mfma_f32_32x32x16_bf16 v[100:115], v[192:195], v[68:71], v[100:115]
    v_add3_u32 v14, v68, v69, v14
    v_add3_u32 v14, v70, v71, v14
    s_waitcnt vmcnt(5)
    v_mfma_f32_32x32x16_bf16 v[100:115], v[192:195], v[72:75], v[100:115]
    v_add3_u32 v14, v72, v73, v14
    v_add3_u32 v14, v74, v75, v14
    s_waitcnt vmcnt(4)
    v_mfma_f32_32x32x16_bf16 v[100:115], v[192:195], v[76:79], v[100:115]
    v_add3_u32 v14, v76, v77, v14
    v_add3_u32 v14, v78, v79, v14
    s_waitcnt vmcnt(3)
    v_mfma_f32_32x32x16_bf16 v[100:115], v[192:195], v[80:83], v[100:115]
    v_add3_u32 v14, v80, v81, v14
    v_add3_u32 v14, v82, v83, v14
    s_waitcnt vmcnt(2)
    v_mfma_f32_32x32x16_bf16 v[100:115], v[192:195], v[84:87], v[100:115]
    v_add3_u32 v14, v84, v85, v14
    v_add3_u32 v14, v86, v87, v14
    s_waitcnt vmcnt(1)
    v_mfma_f32_32x32x16_bf16 v[100:115], v[192:195], v[88:91], v[100:115]
    v_add3_u32 v14, v88, v89, v14
    v_add3_u32 v14, v90, v91, v14
    s_waitcnt vmcnt(0)
    v_mfma_f32_32x32x16_bf16 v[100:115], v[192:195], v[92:95], v[100:115]
    v_add3_u32 v14, v92, v93, v14
    v_add3_u32 v14, v94, v95, v14
    s_waitcnt vmcnt(0) lgkmcnt(0)
    s_nop 8
    s_branch L_cont_b
L_slow_c:
    s_waitcnt vmcnt(0) lgkmcnt(0)
    v_lshlrev_b32 v224, 16, v240
    v_and_b32 v225, 0xffff0000, v240
    v_lshlrev_b32 v226, 16, v241
    v_and_b32 v227, 0xffff0000, v241
    v_lshlrev_b32 v228, 16, v242
    v_and_b32 v229, 0xffff0000, v242
    v_lshlrev_b32 v230, 16, v243
    v_and_b32 v231, 0xffff0000, v243
    v_lshlrev_b32 v232, 16, v244
    v_and_b32 v233, 0xffff0000, v244
    v_lshlrev_b32 v234, 16, v245
    v_and_b32 v235, 0xffff0000, v245
    v_lshlrev_b32 v236, 16, v246
    v_and_b32 v237, 0xffff0000, v246
    v_lshlrev_b32 v238, 16, v247
    v_and_b32 v239, 0xffff0000, v247
    ds_read_b64_tr_b16 v[96:97], v10 offset:0
    ds_read_b64_tr_b16 v[98:99], v16 offset:0
    ds_read_b64_tr_b16 v[100:101], v11 offset:0
    ds_read_b64_tr_b16 v[102:103], v17 offset:0
    ds_read_b64_tr_b16 v[104:105], v12 offset:0
    ds_read_b64_tr_b16 v[106:107], v18 offset:0
    ds_read_b64_tr_b16 v[108:109], v13 offset:0
    ds_read_b64_tr_b16 v[110:111], v19 offset:0
    ds_read_b64_tr_b16 v[112:113], v12 offset:3584
    ds_read_b64_tr_b16 v[114:115], v18 offset:3584
    ds_read_b64_tr_b16 v[116:117], v13 offset:3584
    ds_read_b64_tr_b16 v[118:119], v19 offset:3584
    ds_read_b64_tr_b16 v[120:121], v10 offset:3584
    ds_read_b64_tr_b16 v[122:123], v16 offset:3584
    ds_read_b64_tr_b16 v[124:125], v11 offset:3584
    ds_read_b64_tr_b16 v[126:127], v17 offset:3584
    ds_read_b64_tr_b16 v[128:129], v10 offset:7168
    ds_read_b64_tr_b16 v[130:131], v16 offset:7168
    ds_read_b64_tr_b16 v[132:133], v11 offset:7168
    ds_read_b64_tr_b16 v[134:135], v17 offset:7168
    ds_read_b64_tr_b16 v[136:137], v12 offset:7168
    ds_read_b64_tr_b16 v[138:139], v18 offset:7168
    ds_read_b64_tr_b16 v[140:141], v13 offset:7168
    ds_read_b64_tr_b16 v[142:143], v19 offset:7168
    ds_read_b64_tr_b16 v[144:145], v12 offset:10752
    ds_read_b64_tr_b16 v[146:147], v18 offset:10752
    ds_read_b64_tr_b16 v[148:149], v13 offset:10752
    ds_read_b64_tr_b16 v[150:151], v19 offset:10752
    ds_read_b64_tr_b16 v[152:153], v10 offset:10752
    ds_read_b64_tr_b16 v[154:155], v16 offset:10752
    ds_read_b64_tr_b16 v[156:157], v11 offset:10752
    ds_read_b64_tr_b16 v[158:159], v17 offset:10752
    ds_read_b64_tr_b16 v[160:161], v10 offset:14336
    ds_read_b64_tr_b16 v[162:163], v16 offset:14336
    ds_read_b64_tr_b16 v[164:165], v11 offset:14336
    ds_read_b64_tr_b16 v[166:167], v17 offset:14336
    ds_read_b64_tr_b16 v[168:169], v12 offset:14336
    ds_read_b64_tr_b16 v[170:171], v18 offset:14336
    ds_read_b64_tr_b16 v[172:173], v13 offset:14336
    ds_read_b64_tr_b16 v[174:175], v19 offset:14336
    ds_read_b64_tr_b16 v[176:177], v12 offset:17920
    ds_read_b64_tr_b16 v[178:179], v18 offset:17920
    ds_read_b64_tr_b16 v[180:181], v13 offset:17920
    ds_read_b64_tr_b16 v[182:183], v19 offset:17920
    ds_read_b64_tr_b16 v[184:185], v10 offset:17920
    ds_read_b64_tr_b16 v[186:187], v16 offset:17920
    ds_read_b64_tr_b16 v[188:189], v11 offset:17920
    ds_read_b64_tr_b16 v[190:191], v17 offset:17920
    ds_read_b64_tr_b16 v[192:193], v10 offset:21504
    ds_read_b64_tr_b16 v[194:195], v16 offset:21504
    ds_read_b64_tr_b16 v[196:197], v11 offset:21504
    ds_read_b64_tr_b16 v[198:199], v17 offset:21504
    ds_read_b64_tr_b16 v[200:201], v12 offset:21504
    ds_read_b64_tr_b16 v[202:203], v18 offset:21504
    ds_read_b64_tr_b16 v[204:205], v13 offset:21504
    ds_read_b64_tr_b16 v[206:207], v19 offset:21504
    ds_read_b64_tr_b16 v[208:209], v12 offset:25088
    ds_read_b64_tr_b16 v[210:211], v18 offset:25088
    ds_read_b64_tr_b16 v[212:213], v13 offset:25088
    ds_read_b64_tr_b16 v[214:215], v19 offset:25088
    ds_read_b64_tr_b16 v[216:217], v10 offset:25088
    ds_read_b64_tr_b16 v[218:219], v16 offset:25088
    ds_read_b64_tr_b16 v[220:221], v11 offset:25088
    ds_read_b64_tr_b16 v[222:223], v17 offset:25088
    ds_read_b64_tr_b16 v[24:25], v10 offset:28672
    ds_read_b64_tr_b16 v[26:27], v16 offset:28672
    ds_read_b64_tr_b16 v[28:29], v11 offset:28672
    ds_read_b64_tr_b16 v[30:31], v17 offset:28672
    ds_read_b64_tr_b16 a[224:225], v12 offset:28672
    ds_read_b64_tr_b16 a[226:227], v18 offset:28672
    ds_read_b64_tr_b16 a[228:229], v13 offset:28672
    ds_read_b64_tr_b16 a[230:231], v19 offset:28672
    ds_read_b64_tr_b16 a[232:233], v12 offset:32256
    ds_read_b64_tr_b16 a[234:235], v18 offset:32256
    ds_read_b64_tr_b16 a[236:237], v13 offset:32256
    ds_read_b64_tr_b16 a[238:239], v19 offset:32256
    ds_read_b64_tr_b16 a[240:241], v10 offset:32256
    ds_read_b64_tr_b16 a[242:243], v16 offset:32256
    ds_read_b64_tr_b16 a[244:245], v11 offset:32256
    ds_read_b64_tr_b16 a[246:247], v17 offset:32256
    ds_read_b64_tr_b16 a[248:249], v10 offset:35840
    ds_read_b64_tr_b16 a[250:251], v16 offset:35840
    ds_read_b64_tr_b16 a[252:253], v11 offset:35840
    ds_read_b64_tr_b16 a[254:255], v17 offset:35840
    s_xor_b32 s59, s69, 0
    buffer_load_dwordx4 v[32:35], v9, s[40:43], s59 offen offset:0 sc1
    buffer_load_dwordx4 v[36:39], v9, s[40:43], s59 offen offset:1024 sc1
    buffer_load_dwordx4 v[40:43], v9, s[40:43], s59 offen offset:2048 sc1
    buffer_load_dwordx4 v[44:47], v9, s[40:43], s59 offen offset:3072 sc1
    s_xor_b32 s59, s69, 4096
    buffer_load_dwordx4 v[48:51], v9, s[40:43], s59 offen offset:0 sc1
    buffer_load_dwordx4 v[52:55], v9, s[40:43], s59 offen offset:1024 sc1
    buffer_load_dwordx4 v[56:59], v9, s[40:43], s59 offen offset:2048 sc1
    buffer_load_dwordx4 v[60:63], v9, s[40:43], s59 offen offset:3072 sc1
    s_xor_b32 s59, s69, 8192
    buffer_load_dwordx4 v[64:67], v9, s[40:43], s59 offen offset:0 sc1
    buffer_load_dwordx4 v[68:71], v9, s[40:43], s59 offen offset:1024 sc1
    buffer_load_dwordx4 v[72:75], v9, s[40:43], s59 offen offset:2048 sc1
    buffer_load_dwordx4 v[76:79], v9, s[40:43], s59 offen offset:3072 sc1
    s_xor_b32 s59, s69, 12288
    buffer_load_dwordx4 v[80:83], v9, s[40:43], s59 offen offset:0 sc1
    buffer_load_dwordx4 v[84:87], v9, s[40:43], s59 offen offset:1024 sc1
    buffer_load_dwordx4 v[88:91], v9, s[40:43], s59 offen offset:2048 sc1
    buffer_load_dwordx4 v[92:95], v9, s[40:43], s59 offen offset:3072 sc1
    s_waitcnt vmcnt(15) lgkmcnt(15)
    v_mfma_f32_16x16x32_bf16 v[224:227], v[96:99], v[32:35], v[224:227]
    v_add_u32 v15, v32, v33
    v_add3_u32 v15, v34, v35, v15
    v_mfma_f32_16x16x32_bf16 v[228:231], v[100:103], v[32:35], v[228:231]
    v_mfma_f32_16x16x32_bf16 v[232:235], v[104:107], v[32:35], v[232:235]
    v_mfma_f32_16x16x32_bf16 v[236:239], v[108:111], v[32:35], v[236:239]
    ds_read_b64_tr_b16 v[96:97], v12 offset:35840
    ds_read_b64_tr_b16 v[98:99], v18 offset:35840
    ds_read_b64_tr_b16 v[100:101], v13 offset:35840
    ds_read_b64_tr_b16 v[102:103], v19 offset:35840
    ds_read_b64_tr_b16 v[104:105], v12 offset:39424
    ds_read_b64_tr_b16 v[106:107], v18 offset:39424
    ds_read_b64_tr_b16 v[108:109], v13 offset:39424
    ds_read_b64_tr_b16 v[110:111], v19 offset:39424
    s_waitcnt vmcnt(14) lgkmcnt(15)
    v_mfma_f32_16x16x32_bf16 v[224:227], v[112:115], v[36:39], v[224:227]
    v_add3_u32 v15, v36, v37, v15
    v_add3_u32 v15, v38, v39, v15
    v_mfma_f32_16x16x32_bf16 v[228:231], v[116:119], v[36:39], v[228:231]
    v_mfma_f32_16x16x32_bf16 v[232:235], v[120:123], v[36:39], v[232:235]
    v_mfma_f32_16x16x32_bf16 v[236:239], v[124:127], v[36:39], v[236:239]
    ds_read_b64_tr_b16 v[112:113], v10 offset:39424
    ds_read_b64_tr_b16 v[114:115], v16 offset:39424
    ds_read_b64_tr_b16 v[116:117], v11 offset:39424
    ds_read_b64_tr_b16 v[118:119], v17 offset:39424
    ds_read_b64_tr_b16 v[120:121], v10 offset:43008
    ds_read_b64_tr_b16 v[122:123], v16 offset:43008
    ds_read_b64_tr_b16 v[124:125], v11 offset:43008
    ds_read_b64_tr_b16 v[126:127], v17 offset:43008
    s_waitcnt vmcnt(13) lgkmcnt(15)
    v_mfma_f32_16x16x32_bf16 v[224:227], v[128:131], v[40:43], v[224:227]
    v_add3_u32 v15, v40, v41, v15
    v_add3_u32 v15, v42, v43, v15
    v_mfma_f32_16x16x32_bf16 v[228:231], v[132:135], v[40:43], v[228:231]
    v_mfma_f32_16x16x32_bf16 v[232:235], v[136:139], v[40:43], v[232:235]
    v_mfma_f32_16x16x32_bf16 v[236:239], v[140:143], v[40:43], v[236:239]
    ds_read_b64_tr_b16 v[128:129], v12 offset:43008
    ds_read_b64_tr_b16 v[130:131], v18 offset:43008
    ds_read_b64_tr_b16 v[132:133], v13 offset:43008
    ds_read_b64_tr_b16 v[134:135], v19 offset:43008
    ds_read_b64_tr_b16 v[136:137], v12 offset:46592
    ds_read_b64_tr_b16 v[138:139], v18 offset:46592
    ds_read_b64_tr_b16 v[140:141], v13 offset:46592
    ds_read_b64_tr_b16 v[142:143], v19 offset:46592
    s_waitcnt vmcnt(12) lgkmcnt(15)
    v_mfma_f32_16x16x32_bf16 v[224:227], v[144:147], v[44:47], v[224:227]
    v_add3_u32 v15, v44, v45, v15
    v_add3_u32 v15, v46, v47, v15
    v_mfma_f32_16x16x32_bf16 v[228:231], v[148:151], v[44:47], v[228:231]
    v_mfma_f32_16x16x32_bf16 v[232:235], v[152:155], v[44:47], v[232:235]
    v_mfma_f32_16x16x32_bf16 v[236:239], v[156:159], v[44:47], v[236:239]
    ds_read_b64_tr_b16 v[144:145], v10 offset:46592
    ds_read_b64_tr_b16 v[146:147], v16 offset:46592
    ds_read_b64_tr_b16 v[148:149], v11 offset:46592
    ds_read_b64_tr_b16 v[150:151], v17 offset:46592
    ds_read_b64_tr_b16 v[152:153], v10 offset:50176
    ds_read_b64_tr_b16 v[154:155], v16 offset:50176
    ds_read_b64_tr_b16 v[156:157], v11 offset:50176
    ds_read_b64_tr_b16 v[158:159], v17 offset:50176
    s_waitcnt vmcnt(11) lgkmcnt(15)
    v_mfma_f32_16x16x32_bf16 v[224:227], v[160:163], v[48:51], v[224:227]
    v_add3_u32 v15, v48, v49, v15
    v_add3_u32 v15, v50, v51, v15
    v_mfma_f32_16x16x32_bf16 v[228:231], v[164:167], v[48:51], v[228:231]
    v_mfma_f32_16x16x32_bf16 v[232:235], v[168:171], v[48:51], v[232:235]
    v_mfma_f32_16x16x32_bf16 v[236:239], v[172:175], v[48:51], v[236:239]
    ds_read_b64_tr_b16 v[160:161], v12 offset:50176
    ds_read_b64_tr_b16 v[162:163], v18 offset:50176
    ds_read_b64_tr_b16 v[164:165], v13 offset:50176
    ds_read_b64_tr_b16 v[166:167], v19 offset:50176
    ds_read_b64_tr_b16 v[168:169], v12 offset:53760
    ds_read_b64_tr_b16 v[170:171], v18 offset:53760
    ds_read_b64_tr_b16 v[172:173], v13 offset:53760
    ds_read_b64_tr_b16 v[174:175], v19 offset:53760
    s_waitcnt vmcnt(10) lgkmcnt(15)
    v_mfma_f32_16x16x32_bf16 v[224:227], v[176:179], v[52:55], v[224:227]
    v_add3_u32 v15, v52, v53, v15
    v_add3_u32 v15, v54, v55, v15
    v_mfma_f32_16x16x32_bf16 v[228:231], v[180:183], v[52:55], v[228:231]
    v_mfma_f32_16x16x32_bf16 v[232:235], v[184:187], v[52:55], v[232:235]
    v_mfma_f32_16x16x32_bf16 v[236:239], v[188:191], v[52:55], v[236:239]
    ds_read_b64_tr_b16 v[176:177], v10 offset:53760
    ds_read_b64_tr_b16 v[178:179], v16 offset:53760
    ds_read_b64_tr_b16 v[180:181], v11 offset:53760
    ds_read_b64_tr_b16 v[182:183], v17 offset:53760
    s_waitcnt vmcnt(9) lgkmcnt(15)
    v_mfma_f32_16x16x32_bf16 v[224:227], v[192:195], v[56:59], v[224:227]
    v_add3_u32 v15, v56, v57, v15
    v_add3_u32 v15, v58, v59, v15
    v_mfma_f32_16x16x32_bf16 v[228:231], v[196:199], v[56:59], v[228:231]
    v_mfma_f32_16x16x32_bf16 v[232:235], v[200:203], v[56:59], v[232:235]
    v_mfma_f32_16x16x32_bf16 v[236:239], v[204:207], v[56:59], v[236:239]
    s_waitcnt vmcnt(8) lgkmcnt(15)
    v_mfma_f32_16x16x32_bf16 v[224:227], v[208:211], v[60:63], v[224:227]
    v_add3_u32 v15, v60, v61, v15
    v_add3_u32 v15, v62, v63, v15
    v_mfma_f32_16x16x32_bf16 v[228:231], v[212:215], v[60:63], v[228:231]
    v_mfma_f32_16x16x32_bf16 v[232:235], v[216:219], v[60:63], v[232:235]
    v_mfma_f32_16x16x32_bf16 v[236:239], v[220:223], v[60:63], v[236:239]
    s_waitcnt vmcnt(7) lgkmcnt(15)
    v_mfma_f32_16x16x32_bf16 v[224:227], v[24:27], v[64:67], v[224:227]
    v_add3_u32 v15, v64, v65, v15
    v_add3_u32 v15, v66, v67, v15
    v_mfma_f32_16x16x32_bf16 v[228:231], v[28:31], v[64:67], v[228:231]
    v_mfma_f32_16x16x32_bf16 v[232:235], a[224:227], v[64:67], v[232:235]
    v_mfma_f32_16x16x32_bf16 v[236:239], a[228:231], v[64:67], v[236:239]
    s_waitcnt vmcnt(6) lgkmcnt(15)
    v_mfma_f32_16x16x32_bf16 v[224:227], a[232:235], v[68:71], v[224:227]
    v_add3_u32 v15, v68, v69, v15
    v_add3_u32 v15, v70, v71, v15
    v_mfma_f32_16x16x32_bf16 v[228:231], a[236:239], v[68:71], v[228:231]
    v_mfma_f32_16x16x32_bf16 v[232:235], a[240:243], v[68:71], v[232:235]
    v_mfma_f32_16x16x32_bf16 v[236:239], a[244:247], v[68:71], v[236:239]
    s_waitcnt vmcnt(5) lgkmcnt(15)
    v_mfma_f32_16x16x32_bf16 v[224:227], a[248:251], v[72:75], v[224:227]
    v_add3_u32 v15, v72, v73, v15
    v_add3_u32 v15, v74, v75, v15
    v_mfma_f32_16x16x32_bf16 v[228:231], a[252:255], v[72:75], v[228:231]
    v_mfma_f32_16x16x32_bf16 v[232:235], v[96:99], v[72:75], v[232:235]
    v_mfma_f32_16x16x32_bf16 v[236:239], v[100:103], v[72:75], v[236:239]
    s_waitcnt vmcnt(4) lgkmcnt(15)
    v_mfma_f32_16x16x32_bf16 v[224:227], v[104:107], v[76:79], v[224:227]
    v_add3_u32 v15, v76, v77, v15
    v_add3_u32 v15, v78, v79, v15
    v_mfma_f32_16x16x32_bf16 v[228:231], v[108:111], v[76:79], v[228:231]
    v_mfma_f32_16x16x32_bf16 v[232:235], v[112:115], v[76:79], v[232:235]
    v_mfma_f32_16x16x32_bf16 v[236:239], v[116:119], v[76:79], v[236:239]
    s_waitcnt vmcnt(3) lgkmcnt(15)
    v_mfma_f32_16x16x32_bf16 v[224:227], v[120:123], v[80:83], v[224:227]
    v_add3_u32 v15, v80, v81, v15
    v_add3_u32 v15, v82, v83, v15
    v_mfma_f32_16x16x32_bf16 v[228:231], v[124:127], v[80:83], v[228:231]
    v_mfma_f32_16x16x32_bf16 v[232:235], v[128:131], v[80:83], v[232:235]
    v_mfma_f32_16x16x32_bf16 v[236:239], v[132:135], v[80:83], v[236:239]
    s_waitcnt vmcnt(2) lgkmcnt(15)
    v_mfma_f32_16x16x32_bf16 v[224:227], v[136:139], v[84:87], v[224:227]
    v_add3_u32 v15, v84, v85, v15
    v_add3_u32 v15, v86, v87, v15
    v_mfma_f32_16x16x32_bf16 v[228:231], v[140:143], v[84:87], v[228:231]
    v_mfma_f32_16x16x32_bf16 v[232:235], v[144:147], v[84:87], v[232:235]
    v_mfma_f32_16x16x32_bf16 v[236:239], v[148:151], v[84:87], v[236:239]
    s_waitcnt vmcnt(1) lgkmcnt(8)
    v_mfma_f32_16x16x32_bf16 v[224:227], v[152:155], v[88:91], v[224:227]
    v_add3_u32 v15, v88, v89, v15
    v_add3_u32 v15, v90, v91, v15
    v_mfma_f32_16x16x32_bf16 v[228:231], v[156:159], v[88:91], v[228:231]
    v_mfma_f32_16x16x32_bf16 v[232:235], v[160:163], v[88:91], v[232:235]
    v_mfma_f32_16x16x32_bf16 v[236:239], v[164:167], v[88:91], v[236:239]
    s_waitcnt vmcnt(0) lgkmcnt(0)
    v_mfma_f32_16x16x32_bf16 v[224:227], v[168:171], v[92:95], v[224:227]
    v_add3_u32 v15, v92, v93, v15
    v_add3_u32 v15, v94, v95, v15
    v_mfma_f32_16x16x32_bf16 v[228:231], v[172:175], v[92:95], v[228:231]
    v_mfma_f32_16x16x32_bf16 v[232:235], v[176:179], v[92:95], v[232:235]
    v_mfma_f32_16x16x32_bf16 v[236:239], v[180:183], v[92:95], v[236:239]
    s_waitcnt vmcnt(0) lgkmcnt(0)
    s_nop 10
    s_branch L_cont_c
L_slow_d:
    s_waitcnt vmcnt(0) lgkmcnt(0)
    ds_read_b64_tr_b16 v[208:209], v10 offset:0
    ds_read_b64_tr_b16 v[210:211], v10 offset:2048
    ds_read_b64_tr_b16 v[212:213], v11 offset:0
    ds_read_b64_tr_b16 v[214:215], v11 offset:2048
    ds_read_b64_tr_b16 v[216:217], v10 offset:1024
    ds_read_b64_tr_b16 v[218:219], v10 offset:3072
    ds_read_b64_tr_b16 v[220:221], v11 offset:1024
    ds_read_b64_tr_b16 v[222:223], v11 offset:3072
    ds_read_b64_tr_b16 v[224:225], v10 offset:4096
    ds_read_b64_tr_b16 v[226:227], v10 offset:6144
    ds_read_b64_tr_b16 v[228:229], v11 offset:4096
    ds_read_b64_tr_b16 v[230:231], v11 offset:6144
    s_lshl1_add_u32 s59, s72, s69
    buffer_load_dwordx4 v[32:35], v9, s[40:43], s59 offen offset:0 sc1
    buffer_load_dwordx4 v[36:39], v9, s[40:43], s59 offen offset:1024 sc1
    buffer_load_dwordx4 v[40:43], v9, s[40:43], s59 offen offset:2048 sc1
    buffer_load_dwordx4 v[44:47], v9, s[40:43], s59 offen offset:3072 sc1
    s_lshl1_add_u32 s59, s73, s69
    buffer_load_dwordx4 v[48:51], v9, s[40:43], s59 offen offset:0 sc1
    buffer_load_dwordx4 v[52:55], v9, s[40:43], s59 offen offset:1024 sc1
    buffer_load_dwordx4 v[56:59], v9, s[40:43], s59 offen offset:2048 sc1
    buffer_load_dwordx4 v[60:63], v9, s[40:43], s59 offen offset:3072 sc1
    s_lshl1_add_u32 s59, s74, s69
    buffer_load_dwordx4 v[64:67], v9, s[40:43], s59 offen offset:0 sc1
    buffer_load_dwordx4 v[68:71], v9, s[40:43], s59 offen offset:1024 sc1
    buffer_load_dwordx4 v[72:75], v9, s[40:43], s59 offen offset:2048 sc1
    buffer_load_dwordx4 v[76:79], v9, s[40:43], s59 offen offset:3072 sc1
    s_lshl1_add_u32 s59, s75, s69
    buffer_load_dwordx4 v[80:83], v9, s[40:43], s59 offen offset:0 sc1
    buffer_load_dwordx4 v[84:87], v9, s[40:43], s59 offen offset:1024 sc1
    buffer_load_dwordx4 v[88:91], v9, s[40:43], s59 offen offset:2048 sc1
    buffer_load_dwordx4 v[92:95], v9, s[40:43], s59 offen offset:3072 sc1
    s_lshl1_add_u32 s59, s76, s69
    buffer_load_dwordx4 v[96:99], v9, s[40:43], s59 offen offset:0 sc1
    buffer_load_dwordx4 v[100:103], v9, s[40:43], s59 offen offset:1024 sc1
    buffer_load_dwordx4 v[104:107], v9, s[40:43], s59 offen offset:2048 sc1
    buffer_load_dwordx4 v[108:111], v9, s[40:43], s59 offen offset:3072 sc1
    s_lshl1_add_u32 s59, s77, s69
    buffer_load_dwordx4 v[112:115], v9, s[40:43], s59 offen offset:0 sc1
    buffer_load_dwordx4 v[116:119], v9, s[40:43], s59 offen offset:1024 sc1
    buffer_load_dwordx4 v[120:123], v9, s[40:43], s59 offen offset:2048 sc1
    buffer_load_dwordx4 v[124:127], v9, s[40:43], s59 offen offset:3072 sc1
    s_lshl1_add_u32 s59, s78, s69
    buffer_load_dwordx4 v[128:131], v9, s[40:43], s59 offen offset:0 sc1
    buffer_load_dwordx4 v[132:135], v9, s[40:43], s59 offen offset:1024 sc1
    buffer_load_dwordx4 v[136:139], v9, s[40:43], s59 offen offset:2048 sc1
    buffer_load_dwordx4 v[140:143], v9, s[40:43], s59 offen offset:3072 sc1
    s_waitcnt vmcnt(27) lgkmcnt(8)
    v_mfma_f32_32x32x16_bf16 v[144:159], v[208:211], v[32:35], 0
    ds_read_b64_tr_b16 v[232:233], v10 offset:5120
    ds_read_b64_tr_b16 v[234:235], v10 offset:7168
    v_add_u32 v14, v32, v33
    v_add3_u32 v14, v34, v35, v14
    v_mfma_f32_32x32x16_bf16 v[160:175], v[212:215], v[32:35], 0
    ds_read_b64_tr_b16 v[236:237], v11 offset:5120
    ds_read_b64_tr_b16 v[238:239], v11 offset:7168
    s_waitcnt vmcnt(26) lgkmcnt(8)
    v_mfma_f32_32x32x16_bf16 v[144:159], v[216:219], v[36:39], v[144:159]
    ds_read_b64_tr_b16 v[208:209], v10 offset:8192
    ds_read_b64_tr_b16 v[210:211], v10 offset:10240
    v_add3_u32 v14, v36, v37, v14
    v_add3_u32 v14, v38, v39, v14
    v_mfma_f32_32x32x16_bf16 v[160:175], v[220:223], v[36:39], v[160:175]
    ds_read_b64_tr_b16 v[212:213], v11 offset:8192
    ds_read_b64_tr_b16 v[214:215], v11 offset:10240
    s_waitcnt vmcnt(25) lgkmcnt(8)
    v_mfma_f32_32x32x16_bf16 v[144:159], v[224:227], v[40:43], v[144:159]
    ds_read_b64_tr_b16 v[216:217], v10 offset:9216
    ds_read_b64_tr_b16 v[218:219], v10 offset:11264
    v_add3_u32 v14, v40, v41, v14
    v_add3_u32 v14, v42, v43, v14
    v_mfma_f32_32x32x16_bf16 v[160:175], v[228:231], v[40:43], v[160:175]
    ds_read_b64_tr_b16 v[220:221], v11 offset:9216
    ds_read_b64_tr_b16 v[222:223], v11 offset:11264
    s_waitcnt vmcnt(24) lgkmcnt(8)
    v_mfma_f32_32x32x16_bf16 v[144:159], v[232:235], v[44:47], v[144:159]
    ds_read_b64_tr_b16 v[224:225], v10 offset:12288
    ds_read_b64_tr_b16 v[226:227], v10 offset:14336
    v_add3_u32 v14, v44, v45, v14
    v_add3_u32 v14, v46, v47, v14
    v_mfma_f32_32x32x16_bf16 v[160:175], v[236:239], v[44:47], v[160:175]
    ds_read_b64_tr_b16 v[228:229], v11 offset:12288
    ds_read_b64_tr_b16 v[230:231], v11 offset:14336
    s_waitcnt vmcnt(23) lgkmcnt(8)
    v_mfma_f32_32x32x16_bf16 v[144:159], v[208:211], v[48:51], v[144:159]
    ds_read_b64_tr_b16 v[232:233], v10 offset:13312
    ds_read_b64_tr_b16 v[234:235], v10 offset:15360
    v_add3_u32 v14, v48, v49, v14
    v_add3_u32 v14, v50, v51, v14
    v_mfma_f32_32x32x16_bf16 v[160:175], v[212:215], v[48:51], v[160:175]
    ds_read_b64_tr_b16 v[236:237], v11 offset:13312
    ds_read_b64_tr_b16 v[238:239], v11 offset:15360
    s_waitcnt vmcnt(22) lgkmcnt(8)
    v_mfma_f32_32x32x16_bf16 v[144:159], v[216:219], v[52:55], v[144:159]
    ds_read_b64_tr_b16 v[208:209], v10 offset:16384
    ds_read_b64_tr_b16 v[210:211], v10 offset:18432
    v_add3_u32 v14, v52, v53, v14
    v_add3_u32 v14, v54, v55, v14
    v_mfma_f32_32x32x16_bf16 v[160:175], v[220:223], v[52:55], v[160:175]
    ds_read_b64_tr_b16 v[212:213], v11 offset:16384
    ds_read_b64_tr_b16 v[214:215], v11 offset:18432
    s_waitcnt vmcnt(21) lgkmcnt(8)
    v_mfma_f32_32x32x16_bf16 v[144:159], v[224:227], v[56:59], v[144:159]
    ds_read_b64_tr_b16 v[216:217], v10 offset:17408
    ds_read_b64_tr_b16 v[218:219], v10 offset:19456
    v_add3_u32 v14, v56, v57, v14
    v_add3_u32 v14, v58, v59, v14
    v_mfma_f32_32x32x16_bf16 v[160:175], v[228:231], v[56:59], v[160:175]
    ds_read_b64_tr_b16 v[220:221], v11 offset:17408
    ds_read_b64_tr_b16 v[222:223], v11 offset:19456
    s_waitcnt vmcnt(20) lgkmcnt(8)
    v_mfma_f32_32x32x16_bf16 v[144:159], v[232:235], v[60:63], v[144:159]
    ds_read_b64_tr_b16 v[224:225], v10 offset:20480
    ds_read_b64_tr_b16 v[226:227], v10 offset:22528
    v_add3_u32 v14, v60, v61, v14
    v_add3_u32 v14, v62, v63, v14
    v_mfma_f32_32x32x16_bf16 v[160:175], v[236:239], v[60:63], v[160:175]
    ds_read_b64_tr_b16 v[228:229], v11 offset:20480
    ds_read_b64_tr_b16 v[230:231], v11 offset:22528
    s_waitcnt vmcnt(19) lgkmcnt(8)
    v_mfma_f32_32x32x16_bf16 v[144:159], v[208:211], v[64:67], v[144:159]
    ds_read_b64_tr_b16 v[232:233], v10 offset:21504
    ds_read_b64_tr_b16 v[234:235], v10 offset:23552
    v_add3_u32 v14, v64, v65, v14
    v_add3_u32 v14, v66, v67, v14
    v_mfma_f32_32x32x16_bf16 v[160:175], v[212:215], v[64:67], v[160:175]
    ds_read_b64_tr_b16 v[236:237], v11 offset:21504
    ds_read_b64_tr_b16 v[238:239], v11 offset:23552
    s_waitcnt vmcnt(18) lgkmcnt(8)
    v_mfma_f32_32x32x16_bf16 v[144:159], v[216:219], v[68:71], v[144:159]
    ds_read_b64_tr_b16 v[208:209], v10 offset:24576
    ds_read_b64_tr_b16 v[210:211], v10 offset:26624
    v_add3_u32 v14, v68, v69, v14
    v_add3_u32 v14, v70, v71, v14
    v_mfma_f32_32x32x16_bf16 v[160:175], v[220:223], v[68:71], v[160:175]
    ds_read_b64_tr_b16 v[212:213], v11 offset:24576
    ds_read_b64_tr_b16 v[214:215], v11 offset:26624
    s_waitcnt vmcnt(17) lgkmcnt(8)
    v_mfma_f32_32x32x16_bf16 v[144:159], v[224:227], v[72:75], v[144:159]
    ds_read_b64_tr_b16 v[216:217], v10 offset:25600
    ds_read_b64_tr_b16 v[218:219], v10 offset:27648
    v_add3_u32 v14, v72, v73, v14
    v_add3_u32 v14, v74, v75, v14
    v_mfma_f32_32x32x16_bf16 v[160:175], v[228:231], v[72:75], v[160:175]
    ds_read_b64_tr_b16 v[220:221], v11 offset:25600
    ds_read_b64_tr_b16 v[222:223], v11 offset:27648
    s_waitcnt vmcnt(16) lgkmcnt(8)
    v_mfma_f32_32x32x16_bf16 v[144:159], v[232:235], v[76:79], v[144:159]
    ds_read_b64_tr_b16 v[224:225], v10 offset:28672
    ds_read_b64_tr_b16 v[226:227], v10 offset:30720
    v_add3_u32 v14, v76, v77, v14
    v_add3_u32 v14, v78, v79, v14
    v_mfma_f32_32x32x16_bf16 v[160:175], v[236:239], v[76:79], v[160:175]
    ds_read_b64_tr_b16 v[228:229], v11 offset:28672
    ds_read_b64_tr_b16 v[230:231], v11 offset:30720
    s_waitcnt vmcnt(15) lgkmcnt(8)
    v_mfma_f32_32x32x16_bf16 v[144:159], v[208:211], v[80:83], v[144:159]
    ds_read_b64_tr_b16 v[232:233], v10 offset:29696
    ds_read_b64_tr_b16 v[234:235], v10 offset:31744
    v_add3_u32 v14, v80, v81, v14
    v_add3_u32 v14, v82, v83, v14
    v_mfma_f32_32x32x16_bf16 v[160:175], v[212:215], v[80:83], v[160:175]
    ds_read_b64_tr_b16 v[236:237], v11 offset:29696
    ds_read_b64_tr_b16 v[238:239], v11 offset:31744
    s_waitcnt vmcnt(14) lgkmcnt(8)
    v_mfma_f32_32x32x16_bf16 v[144:159], v[216:219], v[84:87], v[144:159]
    ds_read_b64_tr_b16 v[208:209], v10 offset:32768
    ds_read_b64_tr_b16 v[210:211], v10 offset:34816
    v_add3_u32 v14, v84, v85, v14
    v_add3_u32 v14, v86, v87, v14
    v_mfma_f32_32x32x16_bf16 v[160:175], v[220:223], v[84:87], v[160:175]
    ds_read_b64_tr_b16 v[212:213], v11 offset:32768
    ds_read_b64_tr_b16 v[214:215], v11 offset:34816
    s_waitcnt vmcnt(13) lgkmcnt(8)
    v_mfma_f32_32x32x16_bf16 v[144:159], v[224:227], v[88:91], v[144:159]
    ds_read_b64_tr_b16 v[216:217], v10 offset:33792
    ds_read_b64_tr_b16 v[218:219], v10 offset:35840
    v_add3_u32 v14, v88, v89, v14
    v_add3_u32 v14, v90, v91, v14
    v_mfma_f32_32x32x16_bf16 v[160:175], v[228:231], v[88:91], v[160:175]
    ds_read_b64_tr_b16 v[220:221], v11 offset:33792
    ds_read_b64_tr_b16 v[222:223], v11 offset:35840
    s_waitcnt vmcnt(12) lgkmcnt(8)
    v_mfma_f32_32x32x16_bf16 v[144:159], v[232:235], v[92:95], v[144:159]
    ds_read_b64_tr_b16 v[224:225], v10 offset:36864
    ds_read_b64_tr_b16 v[226:227], v10 offset:38912
    v_add3_u32 v14, v92, v93, v14
    v_add3_u32 v14, v94, v95, v14
    v_mfma_f32_32x32x16_bf16 v[160:175], v[236:239], v[92:95], v[160:175]
    ds_read_b64_tr_b16 v[228:229], v11 offset:36864
    ds_read_b64_tr_b16 v[230:231], v11 offset:38912
    s_waitcnt vmcnt(11) lgkmcnt(8)
    v_mfma_f32_32x32x16_bf16 v[144:159], v[208:211], v[96:99], v[144:159]
    ds_read_b64_tr_b16 v[232:233], v10 offset:37888
    ds_read_b64_tr_b16 v[234:235], v10 offset:39936
    v_add3_u32 v14, v96, v97, v14
    v_add3_u32 v14, v98, v99, v14
    v_mfma_f32_32x32x16_bf16 v[160:175], v[212:215], v[96:99], v[160:175]
    ds_read_b64_tr_b16 v[236:237], v11 offset:37888
    ds_read_b64_tr_b16 v[238:239], v11 offset:39936
    s_waitcnt vmcnt(10) lgkmcnt(8)
    v_mfma_f32_32x32x16_bf16 v[144:159], v[216:219], v[100:103], v[144:159]
    ds_read_b64_tr_b16 v[208:209], v10 offset:40960
    ds_read_b64_tr_b16 v[210:211], v10 offset:43008
    v_add3_u32 v14, v100, v101, v14
    v_add3_u32 v14, v102, v103, v14
    v_mfma_f32_32x32x16_bf16 v[160:175], v[220:223], v[100:103], v[160:175]
    ds_read_b64_tr_b16 v[212:213], v11 offset:40960
    ds_read_b64_tr_b16 v[214:215], v11 offset:43008
    s_waitcnt vmcnt(9) lgkmcnt(8)
    v_mfma_f32_32x32x16_bf16 v[144:159], v[224:227], v[104:107], v[144:159]
    ds_read_b64_tr_b16 v[216:217], v10 offset:41984
    ds_read_b64_tr_b16 v[218:219], v10 offset:44032
    v_add3_u32 v14, v104, v105, v14
    v_add3_u32 v14, v106, v107, v14
    v_mfma_f32_32x32x16_bf16 v[160:175], v[228:231], v[104:107], v[160:175]
    ds_read_b64_tr_b16 v[220:221], v11 offset:41984
    ds_read_b64_tr_b16 v[222:223], v11 offset:44032
    s_waitcnt vmcnt(8) lgkmcnt(8)
    v_mfma_f32_32x32x16_bf16 v[144:159], v[232:235], v[108:111], v[144:159]
    ds_read_b64_tr_b16 v[224:225], v10 offset:45056
    ds_read_b64_tr_b16 v[226:227], v10 offset:47104
    v_add3_u32 v14, v108, v109, v14
    v_add3_u32 v14, v110, v111, v14
    v_mfma_f32_32x32x16_bf16 v[160:175], v[236:239], v[108:111], v[160:175]
    ds_read_b64_tr_b16 v[228:229], v11 offset:45056
    ds_read_b64_tr_b16 v[230:231], v11 offset:47104
    s_waitcnt vmcnt(7) lgkmcnt(8)
    v_mfma_f32_32x32x16_bf16 v[144:159], v[208:211], v[112:115], v[144:159]
    ds_read_b64_tr_b16 v[232:233], v10 offset:46080
    ds_read_b64_tr_b16 v[234:235], v10 offset:48128
    v_add3_u32 v14, v112, v113, v14
    v_add3_u32 v14, v114, v115, v14
    v_mfma_f32_32x32x16_bf16 v[160:175], v[212:215], v[112:115], v[160:175]
    ds_read_b64_tr_b16 v[236:237], v11 offset:46080
    ds_read_b64_tr_b16 v[238:239], v11 offset:48128
    s_waitcnt vmcnt(6) lgkmcnt(8)
    v_mfma_f32_32x32x16_bf16 v[144:159], v[216:219], v[116:119], v[144:159]
    ds_read_b64_tr_b16 v[208:209], v10 offset:49152
    ds_read_b64_tr_b16 v[210:211], v10 offset:51200
    v_add3_u32 v14, v116, v117, v14
    v_add3_u32 v14, v118, v119, v14
    v_mfma_f32_32x32x16_bf16 v[160:175], v[220:223], v[116:119], v[160:175]
    ds_read_b64_tr_b16 v[212:213], v11 offset:49152
    ds_read_b64_tr_b16 v[214:215], v11 offset:51200
    s_waitcnt vmcnt(5) lgkmcnt(8)
    v_mfma_f32_32x32x16_bf16 v[144:159], v[224:227], v[120:123], v[144:159]
    ds_read_b64_tr_b16 v[216:217], v10 offset:50176
    ds_read_b64_tr_b16 v[218:219], v10 offset:52224
    v_add3_u32 v14, v120, v121, v14
    v_add3_u32 v14, v122, v123, v14
    v_mfma_f32_32x32x16_bf16 v[160:175], v[228:231], v[120:123], v[160:175]
    ds_read_b64_tr_b16 v[220:221], v11 offset:50176
    ds_read_b64_tr_b16 v[222:223], v11 offset:52224
    s_waitcnt vmcnt(4) lgkmcnt(8)
    v_mfma_f32_32x32x16_bf16 v[144:159], v[232:235], v[124:127], v[144:159]
    ds_read_b64_tr_b16 v[224:225], v10 offset:53248
    ds_read_b64_tr_b16 v[226:227], v10 offset:55296
    v_add3_u32 v14, v124, v125, v14
    v_add3_u32 v14, v126, v127, v14
    v_mfma_f32_32x32x16_bf16 v[160:175], v[236:239], v[124:127], v[160:175]
    ds_read_b64_tr_b16 v[228:229], v11 offset:53248
    ds_read_b64_tr_b16 v[230:231], v11 offset:55296
    s_waitcnt vmcnt(3) lgkmcnt(8)
    v_mfma_f32_32x32x16_bf16 v[144:159], v[208:211], v[128:131], v[144:159]
    ds_read_b64_tr_b16 v[232:233], v10 offset:54272
    ds_read_b64_tr_b16 v[234:235], v10 offset:56320
    v_add3_u32 v14, v128, v129, v14
    v_add3_u32 v14, v130, v131, v14
    v_mfma_f32_32x32x16_bf16 v[160:175], v[212:215], v[128:131], v[160:175]
    ds_read_b64_tr_b16 v[236:237], v11 offset:54272
    ds_read_b64_tr_b16 v[238:239], v11 offset:56320
    s_waitcnt vmcnt(2) lgkmcnt(8)
    v_mfma_f32_32x32x16_bf16 v[144:159], v[216:219], v[132:135], v[144:159]
    v_add3_u32 v14, v132, v133, v14
    v_add3_u32 v14, v134, v135, v14
    v_mfma_f32_32x32x16_bf16 v[160:175], v[220:223], v[132:135], v[160:175]
    s_waitcnt vmcnt(1) lgkmcnt(4)
    v_mfma_f32_32x32x16_bf16 v[144:159], v[224:227], v[136:139], v[144:159]
    v_add3_u32 v14, v136, v137, v14
    v_add3_u32 v14, v138, v139, v14
    v_mfma_f32_32x32x16_bf16 v[160:175], v[228:231], v[136:139], v[160:175]
    s_waitcnt vmcnt(0) lgkmcnt(0)
    v_mfma_f32_32x32x16_bf16 v[144:159], v[232:235], v[140:143], v[144:159]
    v_add3_u32 v14, v140, v141, v14
    v_add3_u32 v14, v142, v143, v14
    v_mfma_f32_32x32x16_bf16 v[160:175], v[236:239], v[140:143], v[160:175]
    ds_read_b64_tr_b16 v[240:241], v12 offset:0
    ds_read_b64_tr_b16 v[242:243], v12 offset:2048
    ds_read_b64_tr_b16 v[208:209], v12 offset:1024
    ds_read_b64_tr_b16 v[210:211], v12 offset:3072
    ds_read_b64_tr_b16 v[212:213], v12 offset:4096
    ds_read_b64_tr_b16 v[214:215], v12 offset:6144
    ds_read_b64_tr_b16 v[216:217], v12 offset:5120
    ds_read_b64_tr_b16 v[218:219], v12 offset:7168
    ds_read_b64_tr_b16 v[220:221], v12 offset:8192
    ds_read_b64_tr_b16 v[222:223], v12 offset:10240
    v_mfma_f32_32x32x16_bf16 v[144:159], v[16:19], v[244:247], v[144:159]
    v_mfma_f32_32x32x16_bf16 v[160:175], v[20:23], v[244:247], v[160:175]
    s_waitcnt vmcnt(0) lgkmcnt(0)
    s_nop 10
    s_branch L_cont_d
L_e_miss0:
    s_mov_b32 s67, 20000
L_e_more0:
    s_mov_b64 s[100:101], vcc
    s_add_u32 s87, s68, 0
    buffer_load_dwordx2 v[248:249], v250, s[40:43], s87 offen sc1
    s_and_b32 s65, s100, 0xff
    s_cbranch_scc0 L_ek_20
    s_lshl2_add_u32 s57, s72, s69
    buffer_load_dwordx4 v[32:35], v16, s[40:43], s57 offen offset:0 sc1
    buffer_load_dwordx4 v[36:39], v17, s[40:43], s57 offen offset:0 sc1
L_ek_20:
    s_and_b32 s65, s100, 0xff00
    s_cbranch_scc0 L_ek_21
    s_lshl2_add_u32 s57, s73, s69
    buffer_load_dwordx4 v[40:43], v16, s[40:43], s57 offen offset:0 sc1
    buffer_load_dwordx4 v[44:47], v17, s[40:43], s57 offen offset:0 sc1
L_ek_21:
    s_and_b32 s65, s100, 0xff0000
    s_cbranch_scc0 L_ek_22
    s_lshl2_add_u32 s57, s74, s69
    buffer_load_dwordx4 v[48:51], v16, s[40:43], s57 offen offset:0 sc1
    buffer_load_dwordx4 v[52:55], v17, s[40:43], s57 offen offset:0 sc1
L_ek_22:
    s_waitcnt vmcnt(0)
    v_cmp_ne_u32 vcc, s26, v248
    s_nop 4
    s_cbranch_vccz L_e_got0
    s_sub_u32 s67, s67, 1
    s_cbranch_scc0 L_e_more0
L_e_got0:
    s_branch L_e_have0
L_e_miss1:
    s_mov_b32 s67, 20000
L_e_more1:
    s_mov_b64 s[100:101], vcc
    s_add_u32 s87, s68, 4096
    buffer_load_dwordx2 v[18:19], v250, s[40:43], s87 offen sc1
    s_and_b32 s65, s100, 0xff
    s_cbranch_scc0 L_ek_23
    s_lshl2_add_u32 s57, s72, s69
    buffer_load_dwordx4 v[88:91], v16, s[40:43], s57 offen offset:2048 sc1
    buffer_load_dwordx4 v[92:95], v17, s[40:43], s57 offen offset:2048 sc1
L_ek_23:
    s_and_b32 s65, s100, 0xff00
    s_cbranch_scc0 L_ek_24
    s_lshl2_add_u32 s57, s73, s69
    buffer_load_dwordx4 v[96:99], v16, s[40:43], s57 offen offset:2048 sc1
    buffer_load_dwordx4 v[100:103], v17, s[40:43], s57 offen offset:2048 sc1
L_ek_24:
    s_and_b32 s65, s100, 0xff0000
    s_cbranch_scc0 L_ek_25
    s_lshl2_add_u32 s57, s74, s69
    buffer_load_dwordx4 v[104:107], v16, s[40:43], s57 offen offset:2048 sc1
    buffer_load_dwordx4 v[108:111], v17, s[40:43], s57 offen offset:2048 sc1
L_ek_25:
    s_and_b32 s65, s100, 0xff000000
    s_cbranch_scc0 L_ek_26
    s_lshl2_add_u32 s57, s75, s69
    buffer_load_dwordx4 v[112:115], v16, s[40:43], s57 offen offset:2048 sc1
    buffer_load_dwordx4 v[116:119], v17, s[40:43], s57 offen offset:2048 sc1
L_ek_26:
    s_and_b32 s65, s101, 0xff
    s_cbranch_scc0 L_ek_27
    s_lshl2_add_u32 s57, s76, s69
    buffer_load_dwordx4 v[120:123], v16, s[40:43], s57 offen offset:2048 sc1
    buffer_load_dwordx4 v[124:127], v17, s[40:43], s57 offen offset:2048 sc1
L_ek_27:
    s_and_b32 s65, s101, 0xff00
    s_cbranch_scc0 L_ek_28
    s_lshl2_add_u32 s57, s77, s69
    buffer_load_dwordx4 v[128:131], v16, s[40:43], s57 offen offset:2048 sc1
    buffer_load_dwordx4 v[132:135], v17, s[40:43], s57 offen offset:2048 sc1
L_ek_28:
    s_and_b32 s65, s101, 0xff0000
    s_cbranch_scc0 L_ek_29
    s_lshl2_add_u32 s57, s78, s69
    buffer_load_dwordx4 v[136:139], v16, s[40:43], s57 offen offset:2048 sc1
    buffer_load_dwordx4 v[140:143], v17, s[40:43], s57 offen offset:2048 sc1
L_ek_29:
    s_waitcnt vmcnt(0)
    v_cmp_ne_u32 vcc, s26, v18
    s_nop 4
    s_cbranch_vccz L_e_got1
    s_sub_u32 s67, s67, 1
    s_cbranch_scc0 L_e_more1
L_e_got1:
    s_branch L_e_have1
L_e_miss2:
    s_mov_b32 s67, 20000
L_e_more2:
    s_mov_b64 s[100:101], vcc
    s_add_u32 s87, s68, 8192
    buffer_load_dwordx2 v[20:21], v250, s[40:43], s87 offen sc1
    s_and_b32 s65, s100, 0xff
    s_cbranch_scc0 L_ek_30
    s_lshl2_add_u32 s57, s72, s69
    s_add_u32 s57, s57, 4096
    buffer_load_dwordx4 v[32:35], v16, s[40:43], s57 offen offset:0 sc1
    buffer_load_dwordx4 v[36:39], v17, s[40:43], s57 offen offset:0 sc1
L_ek_30:
    s_and_b32 s65, s100, 0xff00
    s_cbranch_scc0 L_ek_31
    s_lshl2_add_u32 s57, s73, s69
    s_add_u32 s57, s57, 4096
    buffer_load_dwordx4 v[40:43], v16, s[40:43], s57 offen offset:0 sc1
    buffer_load_dwordx4 v[44:47], v17, s[40:43], s57 offen offset:0 sc1
L_ek_31:
    s_and_b32 s65, s100, 0xff0000
    s_cbranch_scc0 L_ek_32
    s_lshl2_add_u32 s57, s74, s69
    s_add_u32 s57, s57, 4096
    buffer_load_dwordx4 v[48:51], v16, s[40:43], s57 offen offset:0 sc1
    buffer_load_dwordx4 v[52:55], v17, s[40:43], s57 offen offset:0 sc1
L_ek_32:
    s_and_b32 s65, s100, 0xff000000
    s_cbranch_scc0 L_ek_33
    s_lshl2_add_u32 s57, s75, s69
    s_add_u32 s57, s57, 4096
    buffer_load_dwordx4 v[56:59], v16, s[40:43], s57 offen offset:0 sc1
    buffer_load_dwordx4 v[60:63], v17, s[40:43], s57 offen offset:0 sc1
L_ek_33:
    s_and_b32 s65, s101, 0xff
    s_cbranch_scc0 L_ek_34
    s_lshl2_add_u32 s57, s76, s69
    s_add_u32 s57, s57, 4096
    buffer_load_dwordx4 v[64:67], v16, s[40:43], s57 offen offset:0 sc1
    buffer_load_dwordx4 v[68:71], v17, s[40:43], s57 offen offset:0 sc1
L_ek_34:
    s_and_b32 s65, s101, 0xff00
    s_cbranch_scc0 L_ek_35
    s_lshl2_add_u32 s57, s77, s69
    s_add_u32 s57, s57, 4096
    buffer_load_dwordx4 v[72:75], v16, s[40:43], s57 offen offset:0 sc1
    buffer_load_dwordx4 v[76:79], v17, s[40:43], s57 offen offset:0 sc1
L_ek_35:
    s_and_b32 s65, s101, 0xff0000
    s_cbranch_scc0 L_ek_36
    s_lshl2_add_u32 s57, s78, s69
    s_add_u32 s57, s57, 4096
    buffer_load_dwordx4 v[80:83], v16, s[40:43], s57 offen offset:0 sc1
    buffer_load_dwordx4 v[84:87], v17, s[40:43], s57 offen offset:0 sc1
L_ek_36:
    s_waitcnt vmcnt(0)
    v_cmp_ne_u32 vcc, s26, v20
    s_nop 4
    s_cbranch_vccz L_e_got2
    s_sub_u32 s67, s67, 1
    s_cbranch_scc0 L_e_more2
L_e_got2:
    s_branch L_e_have2
L_e_miss3:
    s_mov_b32 s67, 20000
L_e_more3:
    s_mov_b64 s[100:101], vcc
    s_add_u32 s87, s68, 12288
    buffer_load_dwordx2 v[24:25], v250, s[40:43], s87 offen sc1
    s_and_b32 s65, s100, 0xff
    s_cbranch_scc0 L_ek_37
    s_lshl2_add_u32 s57, s72, s69
    s_add_u32 s57, s57, 4096
    buffer_load_dwordx4 v[88:91], v16, s[40:43], s57 offen offset:2048 sc1
    buffer_load_dwordx4 v[92:95], v17, s[40:43], s57 offen offset:2048 sc1
L_ek_37:
    s_and_b32 s65, s100, 0xff00
    s_cbranch_scc0 L_ek_38
    s_lshl2_add_u32 s57, s73, s69
    s_add_u32 s57, s57, 4096
    buffer_load_dwordx4 v[96:99], v16, s[40:43], s57 offen offset:2048 sc1
    buffer_load_dwordx4 v[100:103], v17, s[40:43], s57 offen offset:2048 sc1
L_ek_38:
    s_and_b32 s65, s100, 0xff0000
    s_cbranch_scc0 L_ek_39
    s_lshl2_add_u32 s57, s74, s69
    s_add_u32 s57, s57, 4096
    buffer_load_dwordx4 v[104:107], v16, s[40:43], s57 offen offset:2048 sc1
    buffer_load_dwordx4 v[108:111], v17, s[40:43], s57 offen offset:2048 sc1
L_ek_39:
    s_and_b32 s65, s100, 0xff000000
    s_cbranch_scc0 L_ek_40
    s_lshl2_add_u32 s57, s75, s69
    s_add_u32 s57, s57, 4096
    buffer_load_dwordx4 v[112:115], v16, s[40:43], s57 offen offset:2048 sc1
    buffer_load_dwordx4 v[116:119], v17, s[40:43], s57 offen offset:2048 sc1
L_ek_40:
    s_and_b32 s65, s101, 0xff
    s_cbranch_scc0 L_ek_41
    s_lshl2_add_u32 s57, s76, s69
    s_add_u32 s57, s57, 4096
    buffer_load_dwordx4 v[120:123], v16, s[40:43], s57 offen offset:2048 sc1
    buffer_load_dwordx4 v[124:127], v17, s[40:43], s57 offen offset:2048 sc1
L_ek_41:
    s_and_b32 s65, s101, 0xff00
    s_cbranch_scc0 L_ek_42
    s_lshl2_add_u32 s57, s77, s69
    s_add_u32 s57, s57, 4096
    buffer_load_dwordx4 v[128:131], v16, s[40:43], s57 offen offset:2048 sc1
    buffer_load_dwordx4 v[132:135], v17, s[40:43], s57 offen offset:2048 sc1
L_ek_42:
    s_and_b32 s65, s101, 0xff0000
    s_cbranch_scc0 L_ek_43
    s_lshl2_add_u32 s57, s78, s69
    s_add_u32 s57, s57, 4096
    buffer_load_dwordx4 v[136:139], v16, s[40:43], s57 offen offset:2048 sc1
    buffer_load_dwordx4 v[140:143], v17, s[40:43], s57 offen offset:2048 sc1
L_ek_43:
    s_waitcnt vmcnt(0)
    v_cmp_ne_u32 vcc, s26, v24
    s_nop 4
    s_cbranch_vccz L_e_got3
    s_sub_u32 s67, s67, 1
    s_cbranch_scc0 L_e_more3
L_e_got3:
    s_branch L_e_have3
L_slow_e:
    s_waitcnt vmcnt(0) lgkmcnt(0)
    s_lshl2_add_u32 s57, s72, s69
    buffer_load_dwordx4 v[32:35], v16, s[40:43], s57 offen offset:0 sc1
    buffer_load_dwordx4 v[36:39], v17, s[40:43], s57 offen offset:0 sc1
    s_lshl2_add_u32 s57, s73, s69
    buffer_load_dwordx4 v[40:43], v16, s[40:43], s57 offen offset:0 sc1
    buffer_load_dwordx4 v[44:47], v17, s[40:43], s57 offen offset:0 sc1
    s_lshl2_add_u32 s57, s74, s69
    buffer_load_dwordx4 v[48:51], v16, s[40:43], s57 offen offset:0 sc1
    buffer_load_dwordx4 v[52:55], v17, s[40:43], s57 offen offset:0 sc1
    s_lshl2_add_u32 s57, s75, s69
    buffer_load_dwordx4 v[56:59], v16, s[40:43], s57 offen offset:0 sc1
    buffer_load_dwordx4 v[60:63], v17, s[40:43], s57 offen offset:0 sc1
    s_lshl2_add_u32 s57, s76, s69
    buffer_load_dwordx4 v[64:67], v16, s[40:43], s57 offen offset:0 sc1
    buffer_load_dwordx4 v[68:71], v17, s[40:43], s57 offen offset:0 sc1
    s_lshl2_add_u32 s57, s77, s69
    buffer_load_dwordx4 v[72:75], v16, s[40:43], s57 offen offset:0 sc1
    buffer_load_dwordx4 v[76:79], v17, s[40:43], s57 offen offset:0 sc1
    s_lshl2_add_u32 s57, s78, s69
    buffer_load_dwordx4 v[80:83], v16, s[40:43], s57 offen offset:0 sc1
    buffer_load_dwordx4 v[84:87], v17, s[40:43], s57 offen offset:0 sc1
    s_lshl2_add_u32 s57, s72, s69
    buffer_load_dwordx4 v[88:91], v16, s[40:43], s57 offen offset:2048 sc1
    buffer_load_dwordx4 v[92:95], v17, s[40:43], s57 offen offset:2048 sc1
    s_lshl2_add_u32 s57, s73, s69
    buffer_load_dwordx4 v[96:99], v16, s[40:43], s57 offen offset:2048 sc1
    buffer_load_dwordx4 v[100:103], v17, s[40:43], s57 offen offset:2048 sc1
    s_lshl2_add_u32 s57, s74, s69
    buffer_load_dwordx4 v[104:107], v16, s[40:43], s57 offen offset:2048 sc1
    buffer_load_dwordx4 v[108:111], v17, s[40:43], s57 offen offset:2048 sc1
    s_lshl2_add_u32 s57, s75, s69
    buffer_load_dwordx4 v[112:115], v16, s[40:43], s57 offen offset:2048 sc1
    buffer_load_dwordx4 v[116:119], v17, s[40:43], s57 offen offset:2048 sc1
    s_lshl2_add_u32 s57, s76, s69
    buffer_load_dwordx4 v[120:123], v16, s[40:43], s57 offen offset:2048 sc1
    buffer_load_dwordx4 v[124:127], v17, s[40:43], s57 offen offset:2048 sc1
    s_lshl2_add_u32 s57, s77, s69
    buffer_load_dwordx4 v[128:131], v16, s[40:43], s57 offen offset:2048 sc1
    buffer_load_dwordx4 v[132:135], v17, s[40:43], s57 offen offset:2048 sc1
    s_lshl2_add_u32 s57, s78, s69
    buffer_load_dwordx4 v[136:139], v16, s[40:43], s57 offen offset:2048 sc1
    buffer_load_dwordx4 v[140:143], v17, s[40:43], s57 offen offset:2048 sc1
    s_waitcnt vmcnt(26)
    v_mfma_f32_32x32x16_bf16 v[144:159], a[0:3], v[32:35], 0
    v_add_u32 v22, v32, v33
    v_add3_u32 v22, v34, v35, v22
    v_mfma_f32_32x32x16_bf16 v[160:175], a[4:7], v[32:35], 0
    v_add3_u32 v22, v36, v37, v22
    v_add3_u32 v22, v38, v39, v22
    v_mfma_f32_32x32x16_bf16 v[176:191], a[0:3], v[36:39], 0
    v_mfma_f32_32x32x16_bf16 v[192:207], a[4:7], v[36:39], 0
    s_lshl2_add_u32 s57, s72, s69
    s_add_u32 s57, s57, 4096
    buffer_load_dwordx4 v[32:35], v16, s[40:43], s57 offen offset:0 sc1
    buffer_load_dwordx4 v[36:39], v17, s[40:43], s57 offen offset:0 sc1
    s_waitcnt vmcnt(26)
    v_mfma_f32_32x32x16_bf16 v[144:159], a[8:11], v[40:43], v[144:159]
    v_add3_u32 v22, v40, v41, v22
    v_add3_u32 v22, v42, v43, v22
    v_mfma_f32_32x32x16_bf16 v[160:175], a[12:15], v[40:43], v[160:175]
    v_add3_u32 v22, v44, v45, v22
    v_add3_u32 v22, v46, v47, v22
    v_mfma_f32_32x32x16_bf16 v[176:191], a[8:11], v[44:47], v[176:191]
    v_mfma_f32_32x32x16_bf16 v[192:207], a[12:15], v[44:47], v[192:207]
    s_lshl2_add_u32 s57, s73, s69
    s_add_u32 s57, s57, 4096
    buffer_load_dwordx4 v[40:43], v16, s[40:43], s57 offen offset:0 sc1
    buffer_load_dwordx4 v[44:47], v17, s[40:43], s57 offen offset:0 sc1
    s_waitcnt vmcnt(26)
    v_mfma_f32_32x32x16_bf16 v[144:159], a[16:19], v[48:51], v[144:159]
    v_add3_u32 v22, v48, v49, v22
    v_add3_u32 v22, v50, v51, v22
    v_mfma_f32_32x32x16_bf16 v[160:175], a[20:23], v[48:51], v[160:175]
    v_add3_u32 v22, v52, v53, v22
    v_add3_u32 v22, v54, v55, v22
    v_mfma_f32_32x32x16_bf16 v[176:191], a[16:19], v[52:55], v[176:191]
    v_mfma_f32_32x32x16_bf16 v[192:207], a[20:23], v[52:55], v[192:207]
    s_lshl2_add_u32 s57, s74, s69
    s_add_u32 s57, s57, 4096
    buffer_load_dwordx4 v[48:51], v16, s[40:43], s57 offen offset:0 sc1
    buffer_load_dwordx4 v[52:55], v17, s[40:43], s57 offen offset:0 sc1
    s_waitcnt vmcnt(26)
    v_mfma_f32_32x32x16_bf16 v[144:159], a[24:27], v[56:59], v[144:159]
    v_add3_u32 v22, v56, v57, v22
    v_add3_u32 v22, v58, v59, v22
    v_mfma_f32_32x32x16_bf16 v[160:175], a[28:31], v[56:59], v[160:175]
    v_add3_u32 v22, v60, v61, v22
    v_add3_u32 v22, v62, v63, v22
    v_mfma_f32_32x32x16_bf16 v[176:191], a[24:27], v[60:63], v[176:191]
    v_mfma_f32_32x32x16_bf16 v[192:207], a[28:31], v[60:63], v[192:207]
    s_lshl2_add_u32 s57, s75, s69
    s_add_u32 s57, s57, 4096
    buffer_load_dwordx4 v[56:59], v16, s[40:43], s57 offen offset:0 sc1
    buffer_load_dwordx4 v[60:63], v17, s[40:43], s57 offen offset:0 sc1
    s_waitcnt vmcnt(26)
    v_mfma_f32_32x32x16_bf16 v[144:159], a[32:35], v[64:67], v[144:159]
    v_add3_u32 v22, v64, v65, v22
    v_add3_u32 v22, v66, v67, v22
    v_mfma_f32_32x32x16_bf16 v[160:175], a[36:39], v[64:67], v[160:175]
    v_add3_u32 v22, v68, v69, v22
    v_add3_u32 v22, v70, v71, v22
    v_mfma_f32_32x32x16_bf16 v[176:191], a[32:35], v[68:71], v[176:191]
    v_mfma_f32_32x32x16_bf16 v[192:207], a[36:39], v[68:71], v[192:207]
    s_lshl2_add_u32 s57, s76, s69
    s_add_u32 s57, s57, 4096
    buffer_load_dwordx4 v[64:67], v16, s[40:43], s57 offen offset:0 sc1
    buffer_load_dwordx4 v[68:71], v17, s[40:43], s57 offen offset:0 sc1
    s_waitcnt vmcnt(26)
    v_mfma_f32_32x32x16_bf16 v[144:159], a[40:43], v[72:75], v[144:159]
    v_add3_u32 v22, v72, v73, v22
    v_add3_u32 v22, v74, v75, v22
    v_mfma_f32_32x32x16_bf16 v[160:175], a[44:47], v[72:75], v[160:175]
    v_add3_u32 v22, v76, v77, v22
    v_add3_u32 v22, v78, v79, v22
    v_mfma_f32_32x32x16_bf16 v[176:191], a[40:43], v[76:79], v[176:191]
    v_mfma_f32_32x32x16_bf16 v[192:207], a[44:47], v[76:79], v[192:207]
    s_lshl2_add_u32 s57, s77, s69
    s_add_u32 s57, s57, 4096
    buffer_load_dwordx4 v[72:75], v16, s[40:43], s57 offen offset:0 sc1
    buffer_load_dwordx4 v[76:79], v17, s[40:43], s57 offen offset:0 sc1
    s_waitcnt vmcnt(26)
    v_mfma_f32_32x32x16_bf16 v[144:159], a[48:51], v[80:83], v[144:159]
    v_add3_u32 v22, v80, v81, v22
    v_add3_u32 v22, v82, v83, v22
    v_mfma_f32_32x32x16_bf16 v[160:175], a[52:55], v[80:83], v[160:175]
    v_add3_u32 v22, v84, v85, v22
    v_add3_u32 v22, v86, v87, v22
    v_mfma_f32_32x32x16_bf16 v[176:191], a[48:51], v[84:87], v[176:191]
    v_mfma_f32_32x32x16_bf16 v[192:207], a[52:55], v[84:87], v[192:207]
    s_lshl2_add_u32 s57, s78, s69
    s_add_u32 s57, s57, 4096
    buffer_load_dwordx4 v[80:83], v16, s[40:43], s57 offen offset:0 sc1
    buffer_load_dwordx4 v[84:87], v17, s[40:43], s57 offen offset:0 sc1
    s_waitcnt vmcnt(26)
    v_mfma_f32_32x32x16_bf16 v[144:159], a[56:59], v[88:91], v[144:159]
    v_add3_u32 v22, v88, v89, v22
    v_add3_u32 v22, v90, v91, v22
    v_mfma_f32_32x32x16_bf16 v[160:175], a[60:63], v[88:91], v[160:175]
    v_add3_u32 v22, v92, v93, v22
    v_add3_u32 v22, v94, v95, v22
    v_mfma_f32_32x32x16_bf16 v[176:191], a[56:59], v[92:95], v[176:191]
    v_mfma_f32_32x32x16_bf16 v[192:207], a[60:63], v[92:95], v[192:207]
    s_lshl2_add_u32 s57, s72, s69
    s_add_u32 s57, s57, 4096
    buffer_load_dwordx4 v[88:91], v16, s[40:43], s57 offen offset:2048 sc1
    buffer_load_dwordx4 v[92:95], v17, s[40:43], s57 offen offset:2048 sc1
    s_waitcnt vmcnt(26)
    v_mfma_f32_32x32x16_bf16 v[144:159], a[64:67], v[96:99], v[144:159]
    v_add3_u32 v22, v96, v97, v22
    v_add3_u32 v22, v98, v99, v22
    v_mfma_f32_32x32x16_bf16 v[160:175], a[68:71], v[96:99], v[160:175]
    v_add3_u32 v22, v100, v101, v22
    v_add3_u32 v22, v102, v103, v22
    v_mfma_f32_32x32x16_bf16 v[176:191], a[64:67], v[100:103], v[176:191]
    v_mfma_f32_32x32x16_bf16 v[192:207], a[68:71], v[100:103], v[192:207]
    s_lshl2_add_u32 s57, s73, s69
    s_add_u32 s57, s57, 4096
    buffer_load_dwordx4 v[96:99], v16, s[40:43], s57 offen offset:2048 sc1
    buffer_load_dwordx4 v[100:103], v17, s[40:43], s57 offen offset:2048 sc1
    s_waitcnt vmcnt(26)
    v_mfma_f32_32x32x16_bf16 v[144:159], a[72:75], v[104:107], v[144:159]
    v_add3_u32 v22, v104, v105, v22
    v_add3_u32 v22, v106, v107, v22
    v_mfma_f32_32x32x16_bf16 v[160:175], a[76:79], v[104:107], v[160:175]
    v_add3_u32 v22, v108, v109, v22
    v_add3_u32 v22, v110, v111, v22
    v_mfma_f32_32x32x16_bf16 v[176:191], a[72:75], v[108:111], v[176:191]
    v_mfma_f32_32x32x16_bf16 v[192:207], a[76:79], v[108:111], v[192:207]
    s_lshl2_add_u32 s57, s74, s69
    s_add_u32 s57, s57, 4096
    buffer_load_dwordx4 v[104:107], v16, s[40:43], s57 offen offset:2048 sc1
    buffer_load_dwordx4 v[108:111], v17, s[40:43], s57 offen offset:2048 sc1
    s_waitcnt vmcnt(26)
    v_mfma_f32_32x32x16_bf16 v[144:159], a[80:83], v[112:115], v[144:159]
    v_add3_u32 v22, v112, v113, v22
    v_add3_u32 v22, v114, v115, v22
    v_mfma_f32_32x32x16_bf16 v[160:175], a[84:87], v[112:115], v[160:175]
    v_add3_u32 v22, v116, v117, v22
    v_add3_u32 v22, v118, v119, v22
    v_mfma_f32_32x32x16_bf16 v[176:191], a[80:83], v[116:119], v[176:191]
    v_mfma_f32_32x32x16_bf16 v[192:207], a[84:87], v[116:119], v[192:207]
    s_lshl2_add_u32 s57, s75, s69
    s_add_u32 s57, s57, 4096
    buffer_load_dwordx4 v[112:115], v16, s[40:43], s57 offen offset:2048 sc1
    buffer_load_dwordx4 v[116:119], v17, s[40:43], s57 offen offset:2048 sc1
    s_waitcnt vmcnt(26)
    v_mfma_f32_32x32x16_bf16 v[144:159], a[88:91], v[120:123], v[144:159]
    v_add3_u32 v22, v120, v121, v22
    v_add3_u32 v22, v122, v123, v22
    v_mfma_f32_32x32x16_bf16 v[160:175], a[92:95], v[120:123], v[160:175]
    v_add3_u32 v22, v124, v125, v22
    v_add3_u32 v22, v126, v127, v22
    v_mfma_f32_32x32x16_bf16 v[176:191], a[88:91], v[124:127], v[176:191]
    v_mfma_f32_32x32x16_bf16 v[192:207], a[92:95], v[124:127], v[192:207]
    s_lshl2_add_u32 s57, s76, s69
    s_add_u32 s57, s57, 4096
    buffer_load_dwordx4 v[120:123], v16, s[40:43], s57 offen offset:2048 sc1
    buffer_load_dwordx4 v[124:127], v17, s[40:43], s57 offen offset:2048 sc1
    s_waitcnt vmcnt(26)
    v_mfma_f32_32x32x16_bf16 v[144:159], a[96:99], v[128:131], v[144:159]
    v_add3_u32 v22, v128, v129, v22
    v_add3_u32 v22, v130, v131, v22
    v_mfma_f32_32x32x16_bf16 v[160:175], a[100:103], v[128:131], v[160:175]
    v_add3_u32 v22, v132, v133, v22
    v_add3_u32 v22, v134, v135, v22
    v_mfma_f32_32x32x16_bf16 v[176:191], a[96:99], v[132:135], v[176:191]
    v_mfma_f32_32x32x16_bf16 v[192:207], a[100:103], v[132:135], v[192:207]
    s_lshl2_add_u32 s57, s77, s69
    s_add_u32 s57, s57, 4096
    buffer_load_dwordx4 v[128:131], v16, s[40:43], s57 offen offset:2048 sc1
    buffer_load_dwordx4 v[132:135], v17, s[40:43], s57 offen offset:2048 sc1
    s_waitcnt vmcnt(26)
    v_mfma_f32_32x32x16_bf16 v[144:159], a[104:107], v[136:139], v[144:159]
    v_add3_u32 v22, v136, v137, v22
    v_add3_u32 v22, v138, v139, v22
    v_mfma_f32_32x32x16_bf16 v[160:175], a[108:111], v[136:139], v[160:175]
    v_add3_u32 v22, v140, v141, v22
    v_add3_u32 v22, v142, v143, v22
    v_mfma_f32_32x32x16_bf16 v[176:191], a[104:107], v[140:143], v[176:191]
    v_mfma_f32_32x32x16_bf16 v[192:207], a[108:111], v[140:143], v[192:207]
    s_lshl2_add_u32 s57, s78, s69
    s_add_u32 s57, s57, 4096
    buffer_load_dwordx4 v[136:139], v16, s[40:43], s57 offen offset:2048 sc1
    buffer_load_dwordx4 v[140:143], v17, s[40:43], s57 offen offset:2048 sc1
    s_waitcnt vmcnt(26)
    v_mfma_f32_32x32x16_bf16 v[144:159], a[112:115], v[32:35], v[144:159]
    v_add3_u32 v22, v32, v33, v22
    v_add3_u32 v22, v34, v35, v22
    v_mfma_f32_32x32x16_bf16 v[160:175], a[116:119], v[32:35], v[160:175]
    v_add3_u32 v22, v36, v37, v22
    v_add3_u32 v22, v38, v39, v22
    v_mfma_f32_32x32x16_bf16 v[176:191], a[112:115], v[36:39], v[176:191]
    v_mfma_f32_32x32x16_bf16 v[192:207], a[116:119], v[36:39], v[192:207]
    s_waitcnt vmcnt(24)
    v_mfma_f32_32x32x16_bf16 v[144:159], a[120:123], v[40:43], v[144:159]
    v_add3_u32 v22, v40, v41, v22
    v_add3_u32 v22, v42, v43, v22
    v_mfma_f32_32x32x16_bf16 v[160:175], a[124:127], v[40:43], v[160:175]
    v_add3_u32 v22, v44, v45, v22
    v_add3_u32 v22, v46, v47, v22
    v_mfma_f32_32x32x16_bf16 v[176:191], a[120:123], v[44:47], v[176:191]
    v_mfma_f32_32x32x16_bf16 v[192:207], a[124:127], v[44:47], v[192:207]
    s_waitcnt vmcnt(22)
    v_mfma_f32_32x32x16_bf16 v[144:159], a[128:131], v[48:51], v[144:159]
    v_add3_u32 v22, v48, v49, v22
    v_add3_u32 v22, v50, v51, v22
    v_mfma_f32_32x32x16_bf16 v[160:175], a[132:135], v[48:51], v[160:175]
    v_add3_u32 v22, v52, v53, v22
    v_add3_u32 v22, v54, v55, v22
    v_mfma_f32_32x32x16_bf16 v[176:191], a[128:131], v[52:55], v[176:191]
    v_mfma_f32_32x32x16_bf16 v[192:207], a[132:135], v[52:55], v[192:207]
    s_waitcnt vmcnt(20)
    v_mfma_f32_32x32x16_bf16 v[144:159], a[136:139], v[56:59], v[144:159]
    v_add3_u32 v22, v56, v57, v22
    v_add3_u32 v22, v58, v59, v22
    v_mfma_f32_32x32x16_bf16 v[160:175], a[140:143], v[56:59], v[160:175]
    v_add3_u32 v22, v60, v61, v22
    v_add3_u32 v22, v62, v63, v22
    v_mfma_f32_32x32x16_bf16 v[176:191], a[136:139], v[60:63], v[176:191]
    v_mfma_f32_32x32x16_bf16 v[192:207], a[140:143], v[60:63], v[192:207]
    s_waitcnt vmcnt(18)
    v_mfma_f32_32x32x16_bf16 v[144:159], a[144:147], v[64:67], v[144:159]
    v_add3_u32 v22, v64, v65, v22
    v_add3_u32 v22, v66, v67, v22
    v_mfma_f32_32x32x16_bf16 v[160:175], a[148:151], v[64:67], v[160:175]
    v_add3_u32 v22, v68, v69, v22
    v_add3_u32 v22, v70, v71, v22
    v_mfma_f32_32x32x16_bf16 v[176:191], a[144:147], v[68:71], v[176:191]
    v_mfma_f32_32x32x16_bf16 v[192:207], a[148:151], v[68:71], v[192:207]
    s_waitcnt vmcnt(16)
    v_mfma_f32_32x32x16_bf16 v[144:159], a[152:155], v[72:75], v[144:159]
    v_add3_u32 v22, v72, v73, v22
    v_add3_u32 v22, v74, v75, v22
    v_mfma_f32_32x32x16_bf16 v[160:175], a[156:159], v[72:75], v[160:175]
    v_add3_u32 v22, v76, v77, v22
    v_add3_u32 v22, v78, v79, v22
    v_mfma_f32_32x32x16_bf16 v[176:191], a[152:155], v[76:79], v[176:191]
    v_mfma_f32_32x32x16_bf16 v[192:207], a[156:159], v[76:79], v[192:207]
    s_waitcnt vmcnt(14)
    v_mfma_f32_32x32x16_bf16 v[144:159], a[160:163], v[80:83], v[144:159]
    v_add3_u32 v22, v80, v81, v22
    v_add3_u32 v22, v82, v83, v22
    v_mfma_f32_32x32x16_bf16 v[160:175], a[164:167], v[80:83], v[160:175]
    v_add3_u32 v22, v84, v85, v22
    v_add3_u32 v22, v86, v87, v22
    v_mfma_f32_32x32x16_bf16 v[176:191], a[160:163], v[84:87], v[176:191]
    v_mfma_f32_32x32x16_bf16 v[192:207], a[164:167], v[84:87], v[192:207]
    s_waitcnt vmcnt(12)
    v_mfma_f32_32x32x16_bf16 v[160:175], a[172:175], v[88:91], v[160:175]
    v_add3_u32 v22, v88, v89, v22
    v_add3_u32 v22, v90, v91, v22
    v_add3_u32 v22, v92, v93, v22
    v_add3_u32 v22, v94, v95, v22
    s_waitcnt vmcnt(10)
    v_mfma_f32_32x32x16_bf16 v[160:175], a[180:183], v[96:99], v[160:175]
    v_add3_u32 v22, v96, v97, v22
    v_add3_u32 v22, v98, v99, v22
    v_add3_u32 v22, v100, v101, v22
    v_add3_u32 v22, v102, v103, v22
    s_waitcnt vmcnt(8)
    v_mfma_f32_32x32x16_bf16 v[160:175], a[188:191], v[104:107], v[160:175]
    v_add3_u32 v22, v104, v105, v22
    v_add3_u32 v22, v106, v107, v22
    v_add3_u32 v22, v108, v109, v22
    v_add3_u32 v22, v110, v111, v22
    s_waitcnt vmcnt(6)
    v_mfma_f32_32x32x16_bf16 v[160:175], a[196:199], v[112:115], v[160:175]
    v_add3_u32 v22, v112, v113, v22
    v_add3_u32 v22, v114, v115, v22
    v_add3_u32 v22, v116, v117, v22
    v_add3_u32 v22, v118, v119, v22
    s_waitcnt vmcnt(4)
    v_mfma_f32_32x32x16_bf16 v[160:175], a[204:207], v[120:123], v[160:175]
    v_add3_u32 v22, v120, v121, v22
    v_add3_u32 v22, v122, v123, v22
    v_add3_u32 v22, v124, v125, v22
    v_add3_u32 v22, v126, v127, v22
    s_waitcnt vmcnt(2)
    v_mfma_f32_32x32x16_bf16 v[160:175], a[212:215], v[128:131], v[160:175]
    v_add3_u32 v22, v128, v129, v22
    v_add3_u32 v22, v130, v131, v22
    v_add3_u32 v22, v132, v133, v22
    v_add3_u32 v22, v134, v135, v22
    s_waitcnt vmcnt(0)
    v_mfma_f32_32x32x16_bf16 v[160:175], a[220:223], v[136:139], v[160:175]
    v_add3_u32 v22, v136, v137, v22
    v_add3_u32 v22, v138, v139, v22
    v_add3_u32 v22, v140, v141, v22
    v_add3_u32 v22, v142, v143, v22
    s_waitcnt vmcnt(0) lgkmcnt(0)
    s_nop 6
    s_branch L_cont_e
L_code_end:
    s_endpgm

.section .rodata,"a"
.p2align 6
.amdhsa_kernel sequential_preLN__linear_kernel_hedgehog__dense_activation_squared_relu__prompt_kernel
  .amdhsa_next_free_vgpr 512
  .amdhsa_next_free_sgpr 102
  .amdhsa_accum_offset 256
  .amdhsa_group_segment_fixed_size 0
  .amdhsa_kernarg_size 96
  .amdhsa_user_sgpr_count 2
  .amdhsa_user_sgpr_kernarg_segment_ptr 1
  .amdhsa_system_sgpr_workgroup_id_x 1
.end_amdhsa_kernel
```
